```python
import torch

def _softmax(x, axis=-1):
    return torch.softmax(x, dim=axis)
def _gelu(x):
    return torch.nn.functional.gelu(x, approximate="tanh")
def _silu(x):
    return torch.nn.functional.silu(x)
def _sigmoid(x):
    return torch.sigmoid(x)
def _layernorm(x, axis=-1, eps=1e-5):
    m = x.mean(dim=axis, keepdim=True)
    v = x.var(dim=axis, keepdim=True, unbiased=False)
    return (x - m) / torch.sqrt(v + eps)
def _scatter_add(tgt, idx, src, axis=0):
    return tgt.clone().index_add_(axis, idx, src)
def _segment_sum(src, seg, n):
    out = torch.zeros((n,) + src.shape[1:], dtype=src.dtype)
    return out.index_add_(0, seg, src)
def _pad(x, pw):
    flat = tuple(v for pair in reversed(pw) for v in pair)
    return torch.nn.functional.pad(x, flat)

kernel_name = 'gather_scatter__kernel_systems_refs_featgraph__graph'

def setup_inputs():

    _w = (lambda a: (lambda t: t.to(torch.bfloat16) if t.is_floating_point() else t)(torch.as_tensor(a)))
    N, deg, D = 10000, 64, 64
    E = N * deg
    scale = D ** -0.5
    src = (lambda lo, hi, *s: torch.randint(lo, hi, s))(0, N, E).to(torch.int64)
    dst = (lambda lo, hi, *s: torch.randint(lo, hi, s))(0, N, E).to(torch.int64)
    return {
        "x": _w((lambda *s: torch.randn(*s, dtype=torch.bfloat16) * 0.8)(N, D)),
        "src": _w(src),
        "dst": _w(dst),
        "w_q": _w((lambda *s: torch.randn(*s, dtype=torch.bfloat16) * 0.8)(D, D) * scale),
        "w_v": _w((lambda *s: torch.randn(*s, dtype=torch.bfloat16) * 0.05)(D, D) * scale),
    }

def reference(x, src, dst, w_q, w_v):
    N, D = x.shape
    xs = x[src]
    xd = x[dst]
    q = xd @ w_q
    logits = torch.einsum('ed,ed->e', xs, q) * (float(D) ** -0.5)
    alpha = _sigmoid(logits)
    msg = alpha[:, None] * (xs @ w_v)
    return _segment_sum(msg, dst, N)
```

```asm
; @launch grid=(250,1,1) block=(1024,1,1) lds=120832
.amdgcn_target "amdgcn-amd-amdhsa--gfx950"
.text
.globl gather_scatter__kernel_systems_refs_featgraph__graph_kernel
.p2align 8
.type gather_scatter__kernel_systems_refs_featgraph__graph_kernel,@function
gather_scatter__kernel_systems_refs_featgraph__graph_kernel:
    s_cmp_ge_u32 s2, 250
    s_cbranch_scc1 k_end
    s_load_dwordx16 s[4:19], s[0:1], 0
    v_lshrrev_b32 v4, 6, v0
    v_lshlrev_b32 v7, 4, v0
    s_mul_i32 s3, s2, 10240
    v_readfirstlane_b32 s44, v4
    v_add_u32 v120, s3, v7
    v_and_b32 v6, 63, v0
    s_cmp_ge_u32 s44, 10
    s_cbranch_scc1 k_hinit
    s_waitcnt lgkmcnt(0)
    global_load_dwordx4 v[100:103], v120, s[8:9] sc1 nt
    global_load_dwordx4 v[96:99], v120, s[6:7] sc1 nt
    v_mov_b32 v48, 0
    v_mov_b32 v49, 0
    v_mov_b32 v50, 0
    v_mov_b32 v51, 0
    v_mov_b32 v52, 0
    v_mov_b32 v53, 0
    v_mov_b32 v54, 0
    v_mov_b32 v55, 0
    v_mov_b32 v56, 0
    v_mov_b32 v57, 0
    v_mov_b32 v58, 0
    v_mov_b32 v59, 0
    v_mov_b32 v60, 0
    v_mov_b32 v61, 0
    v_mov_b32 v62, 0
    v_mov_b32 v63, 0
    s_cmp_gt_u32 s44, 4
    s_cbranch_scc1 k_initdone
    v_lshlrev_b32 v21, 2, v0
    v_mul_u32_u24 v22, 656, v6
    v_add_u32 v22, 94592, v22
    s_cmp_eq_u32 s44, 4
    s_cbranch_scc1 k_init2
    v_mov_b32 v22, 0
k_init2:
    ds_write_b32 v21, v22 offset:22528
    s_branch k_initdone
k_hinit:
    s_sub_u32 s26, s44, 10
    v_mov_b32 v16, 4229955456
    v_mov_b32 v17, 4229955456
    v_mov_b32 v18, 4229955456
    v_mov_b32 v19, 4229955456
    v_add_u32 v20, 43008, v7
    ds_write_b128 v20, v[16:19] offset:0
    ds_write_b128 v20, v[16:19] offset:6144
    ds_write_b128 v20, v[16:19] offset:12288
    ds_write_b128 v20, v[16:19] offset:18432
    ds_write_b128 v20, v[16:19] offset:24576
    ds_write_b128 v20, v[16:19] offset:30720
    ds_write_b128 v20, v[16:19] offset:36864
    ds_write_b128 v20, v[16:19] offset:43008
    ds_write_b128 v20, v[16:19] offset:49152
    ds_write_b128 v20, v[16:19] offset:55296
    ds_write_b128 v20, v[16:19] offset:61440
    s_waitcnt lgkmcnt(0)
k_initdone:
    s_load_dword s100, s[18:19], 0
    s_mov_b32 s48, 0xaaaaaaaa
    s_mov_b32 s49, 0xaaaaaaaa
    s_mov_b32 s50, 0xcccccccc
    s_mov_b32 s51, 0xcccccccc
    s_mov_b32 s42, 0xf0
    s_mov_b32 s43, 2097024
    s_mov_b32 s77, 0
    s_mov_b32 s78, 0
    s_mov_b32 s27, 0
    s_mov_b32 s25, 0
    s_mov_b32 s20, s4
    s_and_b32 s21, s5, 0xffff
    s_mov_b32 s22, 1280000
    s_mov_b32 s23, 0x00020000
    s_mov_b32 s32, s18
    s_and_b32 s33, s19, 0xffff
    s_mov_b32 s34, 268435456
    s_mov_b32 s35, 0x00020000
    s_mov_b32 s36, s14
    s_and_b32 s37, s15, 0xffff
    s_mov_b32 s38, 1280000
    s_mov_b32 s39, 0x00020000
    v_and_b32 v1, 3, v0
    v_lshlrev_b32 v1, 4, v1
    s_lshl_b32 s74, s2, 6
    s_add_u32 s74, s74, 4096
    s_mul_i32 s72, s2, 16384
    s_add_u32 s73, s72, 4198400
    s_add_u32 s72, s72, 4096
    v_cmp_gt_u32 vcc, 1000, v0
    s_mov_b64 s[40:41], vcc
    v_mov_b32 v12, 1
    s_mov_b32 s79, -40
    s_waitcnt lgkmcnt(0)
    s_barrier
    v_lshrrev_b32 v115, 2, v0
    v_mul_u32_u24 v112, 144, v115
    v_add_u32 v112, v112, v1
    v_lshlrev_b32 v113, 4, v0
    v_mul_u32_u24 v114, 16384, v115
    v_add_u32 v114, v114, v1
    v_lshlrev_b32 v115, 2, v115
    s_add_u32 s100, s100, 1
    s_mov_b32 s3, s100
    s_lshl_b32 s60, s3, 1
    s_and_b32 s60, s60, 0x7e
    s_lshl_b32 s3, s3, 15
    s_and_b32 s3, s3, 0x00e00000
    s_or_b32 s68, s60, s3
    s_lshr_b32 s3, s100, 8
    s_and_b32 s3, s3, 0x1fe
    s_add_u32 s3, s3, s100
    s_add_u32 s3, s3, 149
    s_lshl_b32 s60, s3, 1
    s_and_b32 s60, s60, 0x7e
    s_lshl_b32 s3, s3, 15
    s_and_b32 s3, s3, 0x00e00000
    s_or_b32 s69, s60, s3
    s_lshr_b32 s3, s100, 16
    s_and_b32 s3, s3, 0x1fe
    s_add_u32 s3, s3, s100
    s_add_u32 s3, s3, 298
    s_lshl_b32 s60, s3, 1
    s_and_b32 s60, s60, 0x7e
    s_lshl_b32 s3, s3, 15
    s_and_b32 s3, s3, 0x00e00000
    s_or_b32 s70, s60, s3
    s_lshr_b32 s3, s100, 24
    s_and_b32 s3, s3, 0x1fe
    s_add_u32 s3, s3, s100
    s_add_u32 s3, s3, 447
    s_lshl_b32 s60, s3, 1
    s_and_b32 s60, s60, 0x7e
    s_lshl_b32 s3, s3, 15
    s_and_b32 s3, s3, 0x00e00000
    s_or_b32 s71, s60, s3
    s_cmp_ge_u32 s44, 10
    s_cbranch_scc1 k_help
    s_waitcnt vmcnt(1)
    v_mul_u32_u24 v24, 52429, v100
    v_mul_u32_u24 v25, 52429, v101
    v_mul_u32_u24 v26, 52429, v102
    v_mul_u32_u24 v27, 52429, v103
    v_lshrrev_b32 v24, 21, v24
    v_lshrrev_b32 v25, 21, v25
    v_lshrrev_b32 v26, 21, v26
    v_lshrrev_b32 v27, 21, v27
    v_lshlrev_b32 v28, 2, v24
    v_lshlrev_b32 v29, 2, v25
    v_lshlrev_b32 v30, 2, v26
    v_lshlrev_b32 v31, 2, v27
    ds_add_rtn_u32 v32, v28, v12 offset:22528
    ds_add_rtn_u32 v33, v29, v12 offset:22528
    ds_add_rtn_u32 v34, v30, v12 offset:22528
    ds_add_rtn_u32 v35, v31, v12 offset:22528
    v_mad_i32_i24 v100, v24, s79, v100
    v_mad_i32_i24 v101, v25, s79, v101
    v_mad_i32_i24 v102, v26, s79, v102
    v_mad_i32_i24 v103, v27, s79, v103
    v_mul_u32_u24 v24, 144, v24
    v_mul_u32_u24 v25, 144, v25
    v_mul_u32_u24 v26, 144, v26
    v_mul_u32_u24 v27, 144, v27
    s_waitcnt vmcnt(0)
    v_lshlrev_b32 v96, 7, v96
    v_lshlrev_b32 v97, 7, v97
    v_lshlrev_b32 v98, 7, v98
    v_lshlrev_b32 v99, 7, v99
    v_lshl_or_b32 v96, v100, 26, v96
    v_lshl_or_b32 v97, v101, 26, v97
    v_lshl_or_b32 v98, v102, 26, v98
    v_lshl_or_b32 v99, v103, 26, v99
    s_waitcnt lgkmcnt(3)
    v_min_u32 v32, 31, v32
    v_lshl_add_u32 v32, v32, 2, v24
    ds_write_b32 v32, v96 offset:53248
    s_waitcnt lgkmcnt(3)
    v_min_u32 v33, 31, v33
    v_lshl_add_u32 v33, v33, 2, v25
    ds_write_b32 v33, v97 offset:53248
    s_waitcnt lgkmcnt(3)
    v_min_u32 v34, 31, v34
    v_lshl_add_u32 v34, v34, 2, v26
    ds_write_b32 v34, v98 offset:53248
    s_waitcnt lgkmcnt(3)
    v_min_u32 v35, 31, v35
    v_lshl_add_u32 v35, v35, 2, v27
    ds_write_b32 v35, v99 offset:53248
    s_branch k_preb2
k_help:
    s_and_b32 s3, s26, 1
    s_lshl_b32 s3, s3, 12
    s_lshr_b32 s101, s26, 1
    s_lshl_b32 s79, s101, 13
    s_add_u32 m0, s79, s3
    s_cmp_eq_u32 s101, 0
    s_cselect_b64 s[60:61], s[10:11], s[12:13]
    s_mul_i32 s79, s2, 5120
    s_cmp_eq_u32 s101, 2
    s_cselect_b64 s[60:61], s[4:5], s[60:61]
    s_cselect_b32 s79, s79, 0
    s_add_u32 s3, s3, s79
    v_lshl_add_u32 v120, v6, 4, s3
    s_lshl_b32 s101, s101, 4
    global_load_lds_dwordx4 v120, s[60:61]
    s_cmp_eq_u32 s26, 5
    s_cbranch_scc1 k_preb2
    global_load_lds_dwordx4 v120, s[60:61] offset:1024
    global_load_lds_dwordx4 v120, s[60:61] offset:2048
    global_load_lds_dwordx4 v120, s[60:61] offset:3072
k_preb2:
    s_waitcnt lgkmcnt(0)
    s_barrier
    ds_read_b32 v31, v115 offset:22528
    ds_read_b128 v[116:119], v112 offset:53248
    ds_read_b128 v[120:123], v112 offset:53312
    s_mov_b64 exec, s[40:41]
    s_waitcnt lgkmcnt(1)
    v_cmp_lt_u32 vcc, 16, v31
    s_cbranch_vccnz k_bigslot
    v_or_b32 v116, s68, v116
    v_or_b32 v117, s69, v117
    v_or_b32 v118, s70, v118
    v_or_b32 v119, s71, v119
    buffer_store_dwordx4 v[116:119], v113, s[32:35], s72 offen sc1
k_stored:
    s_mov_b64 exec, -1
    v_and_b32 v20, 1, v0
    v_lshlrev_b32 v20, 4, v20
    v_mov_b32 v21, 0xffff
    v_lshlrev_b32 v20, v20, v21
    v_cndmask_b32_e64 v2, v20, 0, s[50:51]
    v_cndmask_b32_e64 v3, 0, v20, s[50:51]
    v_mov_b32 v124, 4
    v_mov_b32 v127, 23532
    v_add_u32 v125, 4194304, v114
    v_lshrrev_b32 v15, 4, v0
    v_mul_u32_u24 v126, 144, v15
    v_add_u32 v126, v126, v1
    v_bfe_u32 v20, v0, 2, 2
    v_mul_u32_u24 v4, 656, v15
    v_add_u32 v4, 94592, v4
    v_lshl_add_u32 v4, v20, 2, v4
    v_mul_u32_u24 v7, 288, v15
    v_lshl_add_u32 v7, v1, 1, v7
    v_lshrrev_b32 v21, 1, v20
    v_lshl_add_u32 v7, v21, 7, v7
    v_and_b32 v21, 1, v20
    v_lshl_add_u32 v7, v21, 4, v7
    s_mov_b32 s75, 2
    s_mov_b32 s47, 0
    s_mov_b32 s31, 0
    s_mov_b32 s30, 0
    s_mov_b32 s24, 2
    s_mov_b32 s66, -1
    s_mov_b32 s67, 0
    s_mov_b64 exec, s[40:41]
    s_waitcnt vmcnt(0) lgkmcnt(0)
    s_barrier
    buffer_load_dwordx4 v[8:11], v114, s[32:35], s74 offen sc1
    s_cmp_lt_u32 s44, 10
    s_cbranch_scc1 k_noq
    s_mov_b64 exec, -1
    v_lshrrev_b32 v23, 4, v6
    v_lshl_add_u32 v20, v23, 3, v20
    v_lshlrev_b32 v20, 7, v20
    v_lshrrev_b32 v21, 1, v1
    s_and_b32 s3, s26, 1
    s_lshl_b32 s3, s3, 6
    v_add3_u32 v20, v20, v21, s3
    ds_read_b64_tr_b16 v[24:25], v20 offset:0
    ds_read_b64_tr_b16 v[26:27], v20 offset:512
    ds_read_b64_tr_b16 v[28:29], v20 offset:4096
    ds_read_b64_tr_b16 v[30:31], v20 offset:4608
    ds_read_b64_tr_b16 v[32:33], v20 offset:32
    ds_read_b64_tr_b16 v[34:35], v20 offset:544
    ds_read_b64_tr_b16 v[36:37], v20 offset:4128
    ds_read_b64_tr_b16 v[38:39], v20 offset:4640
    v_and_b32 v21, 15, v0
    v_add_u32 v21, s101, v21
    v_lshlrev_b32 v22, 7, v21
    v_lshl_add_u32 v22, v23, 4, v22
    ds_read_b128 v[104:107], v22 offset:16384
    ds_read_b128 v[108:111], v22 offset:16448
    v_mul_u32_u24 v21, 144, v21
    v_lshl_add_u32 v22, v23, 3, v21
    v_add_u32 v22, s3, v22
    s_waitcnt lgkmcnt(0)
    v_mfma_f32_16x16x32_bf16 v[64:67], v[24:27], v[104:107], 0
    v_mfma_f32_16x16x32_bf16 v[68:71], v[32:35], v[104:107], 0
    v_mfma_f32_16x16x32_bf16 v[64:67], v[28:31], v[108:111], v[64:67]
    v_mfma_f32_16x16x32_bf16 v[68:71], v[36:39], v[108:111], v[68:71]
    s_nop 7
    v_cvt_pk_bf16_f32 v72, v64, v65
    v_cvt_pk_bf16_f32 v73, v66, v67
    v_cvt_pk_bf16_f32 v74, v68, v69
    v_cvt_pk_bf16_f32 v75, v70, v71
    ds_write_b64 v22, v[72:73] offset:25600
    ds_write_b64 v22, v[74:75] offset:25632
    s_mov_b64 exec, s[40:41]
k_noq:
    s_waitcnt vmcnt(0)
k_noq2:
    s_mov_b32 s79, 0
k_recheck:
    v_xor_b32 v20, s68, v8
    v_bitop3_b32 v20, v20, v9, s69 bitop3:0xf6
    v_bitop3_b32 v20, v20, v10, s70 bitop3:0xf6
    v_bitop3_b32 v20, v20, v11, s71 bitop3:0xf6
    v_and_b32 v20, 14680190, v20
    v_cmp_ne_u32 vcc, 0, v20
    s_cbranch_vccnz k_pushlate
k_pushed:
    s_mov_b64 s[62:63], exec
    v_lshrrev_b32 v24, 24, v8
    v_cmpx_gt_u32_e64 s[52:53], s42, v24
    ds_add_rtn_u32 v32, v24, v124 offset:23552
    v_lshrrev_b32 v25, 24, v9
    v_cmpx_gt_u32_e64 s[54:55], s42, v25
    ds_add_rtn_u32 v33, v25, v124 offset:23552
    v_lshrrev_b32 v26, 24, v10
    v_cmpx_gt_u32_e64 s[56:57], s42, v26
    ds_add_rtn_u32 v34, v26, v124 offset:23552
    v_lshrrev_b32 v27, 24, v11
    v_cmpx_gt_u32_e64 s[58:59], s42, v27
    ds_add_rtn_u32 v35, v27, v124 offset:23552
    s_mov_b64 exec, s[62:63]
    v_and_b32 v21, 1, v8
    v_cmp_eq_u32 vcc, 0xf8, v24
    v_cmp_ne_u32_e64 s[28:29], 0, v21
    s_cbranch_vccnz k_markerA
k_markdoneA:
    s_mov_b64 exec, s[28:29]
    s_cbranch_execz k_noBld
    buffer_load_dwordx4 v[36:39], v125, s[32:35], s74 offen sc1
k_noBld:
    s_mov_b64 exec, s[52:53]
    s_waitcnt lgkmcnt(0)
    ds_write_b32 v32, v8
    s_mov_b64 exec, s[54:55]
    ds_write_b32 v33, v9
    s_mov_b64 exec, s[56:57]
    ds_write_b32 v34, v10
    s_mov_b64 exec, s[58:59]
    ds_write_b32 v35, v11
    s_mov_b64 exec, -1
    s_lshl_b32 s79, s44, 2
    v_mov_b32 v13, s79
    s_waitcnt lgkmcnt(0)
    s_barrier
    s_cmp_ge_u32 s44, 10
    s_cbranch_scc1 k_late
    s_setprio 3
    ds_read2_b32 v[8:9], v4 offset0:0 offset1:4
    ds_read2_b32 v[10:11], v4 offset0:8 offset1:12
    ds_read2_b32 v[16:17], v4 offset0:16 offset1:20
    ds_read2_b32 v[18:19], v4 offset0:24 offset1:28
    ds_read_b128 v[40:43], v126 offset:25600
    ds_read_b128 v[44:47], v126 offset:25664
    s_cmp_eq_u64 s[28:29], 0
    s_cbranch_scc1 k_bdoneG
    s_mov_b64 exec, s[28:29]
    s_waitcnt vmcnt(0)
k_bchkG:
    v_xor_b32 v20, s68, v36
    v_bitop3_b32 v20, v20, v37, s69 bitop3:0xf6
    v_bitop3_b32 v20, v20, v38, s70 bitop3:0xf6
    v_bitop3_b32 v20, v20, v39, s71 bitop3:0xf6
    v_and_b32 v20, 14680190, v20
    v_cmp_ne_u32 vcc, 0, v20
    s_cbranch_vccnz k_bretryG
    v_lshrrev_b32 v24, 24, v36
    v_lshrrev_b32 v25, 24, v37
    v_lshrrev_b32 v26, 24, v38
    v_lshrrev_b32 v27, 24, v39
    v_cmpx_gt_u32_e64 s[52:53], s42, v24
    ds_add_rtn_u32 v32, v24, v124 offset:23552
    v_cmpx_gt_u32_e64 s[54:55], s42, v25
    ds_add_rtn_u32 v33, v25, v124 offset:23552
    v_cmpx_gt_u32_e64 s[56:57], s42, v26
    ds_add_rtn_u32 v34, v26, v124 offset:23552
    v_cmpx_gt_u32_e64 s[58:59], s42, v27
    ds_add_rtn_u32 v35, v27, v124 offset:23552
    s_waitcnt lgkmcnt(0)
    ds_write_b32 v35, v39
    s_mov_b64 exec, s[56:57]
    ds_write_b32 v34, v38
    s_mov_b64 exec, s[54:55]
    ds_write_b32 v33, v37
    s_mov_b64 exec, s[52:53]
    ds_write_b32 v32, v36
    s_mov_b64 exec, -1
k_bdoneG:
    s_waitcnt lgkmcnt(0)
    v_max3_u32 v24, v8, v9, v10
    v_max3_u32 v25, v16, v17, v18
    v_max3_u32 v24, v24, v11, v19
    v_max_u32 v24, v24, v25
    v_cmp_le_u32 vcc, 0xf0000000, v24
    s_cmp_eq_u64 vcc, 0
    s_cselect_b32 s79, 128, 0
    s_mov_b64 exec, 1
    v_mov_b32 v24, s79
    ds_write_b32 v13, v24 offset:25152
    ds_add_u32 v127, v12 offset:8
    s_mov_b64 exec, -1
    s_cbranch_scc0 k_gslow
    v_and_or_b32 v8, v8, s43, v1
    v_and_or_b32 v9, v9, s43, v1
    v_and_or_b32 v10, v10, s43, v1
    v_and_or_b32 v11, v11, s43, v1
    buffer_load_dwordx4 v[64:67], v8, s[20:23], 0 offen
    buffer_load_dwordx4 v[68:71], v8, s[20:23], 0 offen offset:64
    buffer_load_dwordx4 v[72:75], v9, s[20:23], 0 offen
    buffer_load_dwordx4 v[76:79], v9, s[20:23], 0 offen offset:64
    buffer_load_dwordx4 v[80:83], v10, s[20:23], 0 offen
    buffer_load_dwordx4 v[84:87], v10, s[20:23], 0 offen offset:64
    buffer_load_dwordx4 v[88:91], v11, s[20:23], 0 offen
    buffer_load_dwordx4 v[92:95], v11, s[20:23], 0 offen offset:64
    v_add_u32 v4, 128, v4
    v_and_or_b32 v16, v16, s43, v1
    v_and_or_b32 v17, v17, s43, v1
    v_and_or_b32 v18, v18, s43, v1
    v_and_or_b32 v19, v19, s43, v1
    buffer_load_dwordx4 v[96:99], v16, s[20:23], 0 offen
    buffer_load_dwordx4 v[100:103], v16, s[20:23], 0 offen offset:64
    buffer_load_dwordx4 v[104:107], v17, s[20:23], 0 offen
    buffer_load_dwordx4 v[108:111], v17, s[20:23], 0 offen offset:64
    buffer_load_dwordx4 v[112:115], v18, s[20:23], 0 offen
    buffer_load_dwordx4 v[116:119], v18, s[20:23], 0 offen offset:64
    buffer_load_dwordx4 v[120:123], v19, s[20:23], 0 offen
    buffer_load_dwordx4 v[124:127], v19, s[20:23], 0 offen offset:64
k_gstarted:
    s_setprio 1
    ds_read2_b32 v[8:9], v4 offset0:0 offset1:4
    ds_read2_b32 v[10:11], v4 offset0:8 offset1:12
    s_waitcnt vmcnt(8)
k_pstart:
    v_mfma_f32_4x4x4_16b_bf16 v[24:27], v[40:41], v[64:65], 0
    v_mfma_f32_4x4x4_16b_bf16 v[28:31], v[40:41], v[72:73], 0
    v_mfma_f32_4x4x4_16b_bf16 v[32:35], v[40:41], v[80:81], 0
    v_mfma_f32_4x4x4_16b_bf16 v[36:39], v[40:41], v[88:89], 0
    v_mfma_f32_4x4x4_16b_bf16 v[24:27], v[42:43], v[66:67], v[24:27]
    v_mfma_f32_4x4x4_16b_bf16 v[28:31], v[42:43], v[74:75], v[28:31]
    v_mfma_f32_4x4x4_16b_bf16 v[32:35], v[42:43], v[82:83], v[32:35]
    v_mfma_f32_4x4x4_16b_bf16 v[36:39], v[42:43], v[90:91], v[36:39]
    v_mfma_f32_4x4x4_16b_bf16 v[24:27], v[44:45], v[68:69], v[24:27]
    v_mfma_f32_4x4x4_16b_bf16 v[28:31], v[44:45], v[76:77], v[28:31]
    v_mfma_f32_4x4x4_16b_bf16 v[32:35], v[44:45], v[84:85], v[32:35]
    v_mfma_f32_4x4x4_16b_bf16 v[36:39], v[44:45], v[92:93], v[36:39]
    v_mfma_f32_4x4x4_16b_bf16 v[24:27], v[46:47], v[70:71], v[24:27]
    v_mfma_f32_4x4x4_16b_bf16 v[28:31], v[46:47], v[78:79], v[28:31]
    v_mfma_f32_4x4x4_16b_bf16 v[32:35], v[46:47], v[86:87], v[32:35]
    v_mfma_f32_4x4x4_16b_bf16 v[36:39], v[46:47], v[94:95], v[36:39]
    s_nop 4
    v_cndmask_b32_e64 v12, v24, v29, s[48:49]
    v_cndmask_b32_e64 v13, v34, v39, s[48:49]
    v_cndmask_b32_e64 v14, v28, v33, s[48:49]
    v_cndmask_b32_e64 v15, v38, v27, s[48:49]
    v_cndmask_b32_e64 v12, v12, v13, s[50:51]
    v_cndmask_b32_e64 v13, v14, v15, s[50:51]
    v_cndmask_b32_e64 v14, v32, v37, s[48:49]
    v_cndmask_b32_e64 v15, v26, v31, s[48:49]
    v_add_f32_dpp v12, v13, v12 quad_perm:[3,0,1,2] row_mask:0xf bank_mask:0xf
    v_cndmask_b32_e64 v14, v14, v15, s[50:51]
    v_cndmask_b32_e64 v13, v36, v25, s[48:49]
    v_cndmask_b32_e64 v15, v30, v35, s[48:49]
    v_add_f32_dpp v12, v14, v12 quad_perm:[2,3,0,1] row_mask:0xf bank_mask:0xf
    v_cndmask_b32_e64 v13, v13, v15, s[50:51]
    s_nop 1
    v_add_f32_dpp v5, v13, v12 quad_perm:[1,2,3,0] row_mask:0xf bank_mask:0xf
k_loop0:
    s_add_u32 s47, s47, 1
    s_cmp_lt_u32 s47, s75
    s_cbranch_scc0 k_last0
    s_waitcnt vmcnt(0)
    v_mfma_f32_4x4x4_16b_bf16 v[24:27], v[40:41], v[96:97], 0
    v_mul_f32_e32 v5, 0xbe38aa3b, v5
    v_mfma_f32_4x4x4_16b_bf16 v[28:31], v[40:41], v[104:105], 0
    v_exp_f32_e32 v5, v5
    v_mfma_f32_4x4x4_16b_bf16 v[32:35], v[40:41], v[112:113], 0
    v_add_f32_e32 v5, 1.0, v5
    v_mfma_f32_4x4x4_16b_bf16 v[36:39], v[40:41], v[120:121], 0
    v_rcp_f32_e32 v5, v5
    v_mfma_f32_4x4x4_16b_bf16 v[24:27], v[42:43], v[98:99], v[24:27]
    v_cvt_pk_bf16_f32 v5, v5, v5
    v_mfma_f32_4x4x4_16b_bf16 v[28:31], v[42:43], v[106:107], v[28:31]
    v_mfma_f32_4x4x4_16b_bf16 v[32:35], v[42:43], v[114:115], v[32:35]
    v_and_b32_dpp v16, v5, v2 quad_perm:[0,0,0,0] row_mask:0xf bank_mask:0xf
    v_mfma_f32_4x4x4_16b_bf16 v[36:39], v[42:43], v[122:123], v[36:39]
    v_and_b32_dpp v17, v5, v3 quad_perm:[0,0,0,0] row_mask:0xf bank_mask:0xf
    v_mfma_f32_4x4x4_16b_bf16 v[24:27], v[44:45], v[100:101], v[24:27]
    v_and_b32_dpp v18, v5, v2 quad_perm:[1,1,1,1] row_mask:0xf bank_mask:0xf
    v_mfma_f32_4x4x4_16b_bf16 v[28:31], v[44:45], v[108:109], v[28:31]
    v_and_b32_dpp v19, v5, v3 quad_perm:[1,1,1,1] row_mask:0xf bank_mask:0xf
    v_mfma_f32_4x4x4_16b_bf16 v[32:35], v[44:45], v[116:117], v[32:35]
    v_and_b32_dpp v20, v5, v2 quad_perm:[2,2,2,2] row_mask:0xf bank_mask:0xf
    v_mfma_f32_4x4x4_16b_bf16 v[36:39], v[44:45], v[124:125], v[36:39]
    v_and_b32_dpp v21, v5, v3 quad_perm:[2,2,2,2] row_mask:0xf bank_mask:0xf
    v_mfma_f32_4x4x4_16b_bf16 v[24:27], v[46:47], v[102:103], v[24:27]
    v_and_b32_dpp v22, v5, v2 quad_perm:[3,3,3,3] row_mask:0xf bank_mask:0xf
    v_mfma_f32_4x4x4_16b_bf16 v[28:31], v[46:47], v[110:111], v[28:31]
    v_and_b32_dpp v23, v5, v3 quad_perm:[3,3,3,3] row_mask:0xf bank_mask:0xf
    v_mfma_f32_4x4x4_16b_bf16 v[32:35], v[46:47], v[118:119], v[32:35]
    v_mfma_f32_4x4x4_16b_bf16 v[36:39], v[46:47], v[126:127], v[36:39]
    s_cmp_lg_u32 s31, 0
    s_cbranch_scc1 k_dc_kl0
    s_getpc_b64 s[64:65]
k_pc0:
    s_add_u32 s64, s64, k_rt0-k_pc0
    s_addc_u32 s65, s65, 0
    s_branch k_resolve
k_rt0:
k_dc_kl0:
    s_mov_b32 s3, 0
    s_cmp_lt_u32 s75, s45
    s_cbranch_scc0 k_dc_endl0
    s_waitcnt lgkmcnt(0)
    v_and_or_b32 v8, v8, s43, v1
    v_and_or_b32 v9, v9, s43, v1
    v_and_or_b32 v10, v10, s43, v1
    v_and_or_b32 v11, v11, s43, v1
    s_add_u32 s75, s75, 1
    v_add_u32 v4, 64, v4
    s_cmp_eq_u32 s75, s45
    s_cselect_b32 s3, s46, 4
k_dc_endl0:
    s_cmp_eq_u32 s3, 4
    s_cbranch_scc0 k_nf0
    v_mfma_f32_4x4x4_16b_bf16 v[48:51], v[16:17], v[64:65], v[48:51]
    v_mfma_f32_4x4x4_16b_bf16 v[52:55], v[16:17], v[66:67], v[52:55]
    v_cndmask_b32_e64 v12, v24, v29, s[48:49]
    v_mfma_f32_4x4x4_16b_bf16 v[56:59], v[16:17], v[68:69], v[56:59]
    v_cndmask_b32_e64 v13, v34, v39, s[48:49]
    v_mfma_f32_4x4x4_16b_bf16 v[60:63], v[16:17], v[70:71], v[60:63]
    v_cndmask_b32_e64 v14, v28, v33, s[48:49]
    buffer_load_dwordx4 v[64:67], v8, s[20:23], 0 offen
    buffer_load_dwordx4 v[68:71], v8, s[20:23], 0 offen offset:64
    v_mfma_f32_4x4x4_16b_bf16 v[48:51], v[18:19], v[72:73], v[48:51]
    v_cndmask_b32_e64 v15, v38, v27, s[48:49]
    v_mfma_f32_4x4x4_16b_bf16 v[52:55], v[18:19], v[74:75], v[52:55]
    v_cndmask_b32_e64 v12, v12, v13, s[50:51]
    v_mfma_f32_4x4x4_16b_bf16 v[56:59], v[18:19], v[76:77], v[56:59]
    v_cndmask_b32_e64 v13, v14, v15, s[50:51]
    v_mfma_f32_4x4x4_16b_bf16 v[60:63], v[18:19], v[78:79], v[60:63]
    v_cndmask_b32_e64 v14, v32, v37, s[48:49]
    buffer_load_dwordx4 v[72:75], v9, s[20:23], 0 offen
    buffer_load_dwordx4 v[76:79], v9, s[20:23], 0 offen offset:64
    v_mfma_f32_4x4x4_16b_bf16 v[48:51], v[20:21], v[80:81], v[48:51]
    v_cndmask_b32_e64 v15, v26, v31, s[48:49]
    v_mfma_f32_4x4x4_16b_bf16 v[52:55], v[20:21], v[82:83], v[52:55]
    v_add_f32_dpp v12, v13, v12 quad_perm:[3,0,1,2] row_mask:0xf bank_mask:0xf
    v_mfma_f32_4x4x4_16b_bf16 v[56:59], v[20:21], v[84:85], v[56:59]
    v_cndmask_b32_e64 v14, v14, v15, s[50:51]
    v_mfma_f32_4x4x4_16b_bf16 v[60:63], v[20:21], v[86:87], v[60:63]
    v_cndmask_b32_e64 v13, v36, v25, s[48:49]
    buffer_load_dwordx4 v[80:83], v10, s[20:23], 0 offen
    buffer_load_dwordx4 v[84:87], v10, s[20:23], 0 offen offset:64
    v_mfma_f32_4x4x4_16b_bf16 v[48:51], v[22:23], v[88:89], v[48:51]
    v_cndmask_b32_e64 v15, v30, v35, s[48:49]
    v_mfma_f32_4x4x4_16b_bf16 v[52:55], v[22:23], v[90:91], v[52:55]
    v_add_f32_dpp v12, v14, v12 quad_perm:[2,3,0,1] row_mask:0xf bank_mask:0xf
    v_mfma_f32_4x4x4_16b_bf16 v[56:59], v[22:23], v[92:93], v[56:59]
    v_cndmask_b32_e64 v13, v13, v15, s[50:51]
    v_mfma_f32_4x4x4_16b_bf16 v[60:63], v[22:23], v[94:95], v[60:63]
    buffer_load_dwordx4 v[88:91], v11, s[20:23], 0 offen
    buffer_load_dwordx4 v[92:95], v11, s[20:23], 0 offen offset:64
    v_add_f32_dpp v5, v13, v12 quad_perm:[1,2,3,0] row_mask:0xf bank_mask:0xf
k_isd0:
    ds_read2_b32 v[8:9], v4 offset0:0 offset1:4
    ds_read2_b32 v[10:11], v4 offset0:8 offset1:12
    s_setprio 0
    s_cmp_eq_u32 s47, s24
    s_cbranch_scc1 k_switch
k_switched0:
k_loop1:
    s_add_u32 s47, s47, 1
    s_cmp_lt_u32 s47, s75
    s_cbranch_scc0 k_last1
    s_waitcnt vmcnt(0)
    v_mfma_f32_4x4x4_16b_bf16 v[24:27], v[40:41], v[64:65], 0
    v_mul_f32_e32 v5, 0xbe38aa3b, v5
    v_mfma_f32_4x4x4_16b_bf16 v[28:31], v[40:41], v[72:73], 0
    v_exp_f32_e32 v5, v5
    v_mfma_f32_4x4x4_16b_bf16 v[32:35], v[40:41], v[80:81], 0
    v_add_f32_e32 v5, 1.0, v5
    v_mfma_f32_4x4x4_16b_bf16 v[36:39], v[40:41], v[88:89], 0
    v_rcp_f32_e32 v5, v5
    v_mfma_f32_4x4x4_16b_bf16 v[24:27], v[42:43], v[66:67], v[24:27]
    v_cvt_pk_bf16_f32 v5, v5, v5
    v_mfma_f32_4x4x4_16b_bf16 v[28:31], v[42:43], v[74:75], v[28:31]
    v_mfma_f32_4x4x4_16b_bf16 v[32:35], v[42:43], v[82:83], v[32:35]
    v_and_b32_dpp v16, v5, v2 quad_perm:[0,0,0,0] row_mask:0xf bank_mask:0xf
    v_mfma_f32_4x4x4_16b_bf16 v[36:39], v[42:43], v[90:91], v[36:39]
    v_and_b32_dpp v17, v5, v3 quad_perm:[0,0,0,0] row_mask:0xf bank_mask:0xf
    v_mfma_f32_4x4x4_16b_bf16 v[24:27], v[44:45], v[68:69], v[24:27]
    v_and_b32_dpp v18, v5, v2 quad_perm:[1,1,1,1] row_mask:0xf bank_mask:0xf
    v_mfma_f32_4x4x4_16b_bf16 v[28:31], v[44:45], v[76:77], v[28:31]
    v_and_b32_dpp v19, v5, v3 quad_perm:[1,1,1,1] row_mask:0xf bank_mask:0xf
    v_mfma_f32_4x4x4_16b_bf16 v[32:35], v[44:45], v[84:85], v[32:35]
    v_and_b32_dpp v20, v5, v2 quad_perm:[2,2,2,2] row_mask:0xf bank_mask:0xf
    v_mfma_f32_4x4x4_16b_bf16 v[36:39], v[44:45], v[92:93], v[36:39]
    v_and_b32_dpp v21, v5, v3 quad_perm:[2,2,2,2] row_mask:0xf bank_mask:0xf
    v_mfma_f32_4x4x4_16b_bf16 v[24:27], v[46:47], v[70:71], v[24:27]
    v_and_b32_dpp v22, v5, v2 quad_perm:[3,3,3,3] row_mask:0xf bank_mask:0xf
    v_mfma_f32_4x4x4_16b_bf16 v[28:31], v[46:47], v[78:79], v[28:31]
    v_and_b32_dpp v23, v5, v3 quad_perm:[3,3,3,3] row_mask:0xf bank_mask:0xf
    v_mfma_f32_4x4x4_16b_bf16 v[32:35], v[46:47], v[86:87], v[32:35]
    v_mfma_f32_4x4x4_16b_bf16 v[36:39], v[46:47], v[94:95], v[36:39]
    s_cmp_lg_u32 s31, 0
    s_cbranch_scc1 k_dc_kl1
    s_getpc_b64 s[64:65]
k_pc1:
    s_add_u32 s64, s64, k_rt1-k_pc1
    s_addc_u32 s65, s65, 0
    s_branch k_resolve
k_rt1:
k_dc_kl1:
    s_mov_b32 s3, 0
    s_cmp_lt_u32 s75, s45
    s_cbranch_scc0 k_dc_endl1
    s_waitcnt lgkmcnt(0)
    v_and_or_b32 v8, v8, s43, v1
    v_and_or_b32 v9, v9, s43, v1
    v_and_or_b32 v10, v10, s43, v1
    v_and_or_b32 v11, v11, s43, v1
    s_add_u32 s75, s75, 1
    v_add_u32 v4, 64, v4
    s_cmp_eq_u32 s75, s45
    s_cselect_b32 s3, s46, 4
k_dc_endl1:
    s_cmp_eq_u32 s3, 4
    s_cbranch_scc0 k_nf1
    v_mfma_f32_4x4x4_16b_bf16 v[48:51], v[16:17], v[96:97], v[48:51]
    v_mfma_f32_4x4x4_16b_bf16 v[52:55], v[16:17], v[98:99], v[52:55]
    v_cndmask_b32_e64 v12, v24, v29, s[48:49]
    v_mfma_f32_4x4x4_16b_bf16 v[56:59], v[16:17], v[100:101], v[56:59]
    v_cndmask_b32_e64 v13, v34, v39, s[48:49]
    v_mfma_f32_4x4x4_16b_bf16 v[60:63], v[16:17], v[102:103], v[60:63]
    v_cndmask_b32_e64 v14, v28, v33, s[48:49]
    buffer_load_dwordx4 v[96:99], v8, s[20:23], 0 offen
    buffer_load_dwordx4 v[100:103], v8, s[20:23], 0 offen offset:64
    v_mfma_f32_4x4x4_16b_bf16 v[48:51], v[18:19], v[104:105], v[48:51]
    v_cndmask_b32_e64 v15, v38, v27, s[48:49]
    v_mfma_f32_4x4x4_16b_bf16 v[52:55], v[18:19], v[106:107], v[52:55]
    v_cndmask_b32_e64 v12, v12, v13, s[50:51]
    v_mfma_f32_4x4x4_16b_bf16 v[56:59], v[18:19], v[108:109], v[56:59]
    v_cndmask_b32_e64 v13, v14, v15, s[50:51]
    v_mfma_f32_4x4x4_16b_bf16 v[60:63], v[18:19], v[110:111], v[60:63]
    v_cndmask_b32_e64 v14, v32, v37, s[48:49]
    buffer_load_dwordx4 v[104:107], v9, s[20:23], 0 offen
    buffer_load_dwordx4 v[108:111], v9, s[20:23], 0 offen offset:64
    v_mfma_f32_4x4x4_16b_bf16 v[48:51], v[20:21], v[112:113], v[48:51]
    v_cndmask_b32_e64 v15, v26, v31, s[48:49]
    v_mfma_f32_4x4x4_16b_bf16 v[52:55], v[20:21], v[114:115], v[52:55]
    v_add_f32_dpp v12, v13, v12 quad_perm:[3,0,1,2] row_mask:0xf bank_mask:0xf
    v_mfma_f32_4x4x4_16b_bf16 v[56:59], v[20:21], v[116:117], v[56:59]
    v_cndmask_b32_e64 v14, v14, v15, s[50:51]
    v_mfma_f32_4x4x4_16b_bf16 v[60:63], v[20:21], v[118:119], v[60:63]
    v_cndmask_b32_e64 v13, v36, v25, s[48:49]
    buffer_load_dwordx4 v[112:115], v10, s[20:23], 0 offen
    buffer_load_dwordx4 v[116:119], v10, s[20:23], 0 offen offset:64
    v_mfma_f32_4x4x4_16b_bf16 v[48:51], v[22:23], v[120:121], v[48:51]
    v_cndmask_b32_e64 v15, v30, v35, s[48:49]
    v_mfma_f32_4x4x4_16b_bf16 v[52:55], v[22:23], v[122:123], v[52:55]
    v_add_f32_dpp v12, v14, v12 quad_perm:[2,3,0,1] row_mask:0xf bank_mask:0xf
    v_mfma_f32_4x4x4_16b_bf16 v[56:59], v[22:23], v[124:125], v[56:59]
    v_cndmask_b32_e64 v13, v13, v15, s[50:51]
    v_mfma_f32_4x4x4_16b_bf16 v[60:63], v[22:23], v[126:127], v[60:63]
    buffer_load_dwordx4 v[120:123], v11, s[20:23], 0 offen
    buffer_load_dwordx4 v[124:127], v11, s[20:23], 0 offen offset:64
    v_add_f32_dpp v5, v13, v12 quad_perm:[1,2,3,0] row_mask:0xf bank_mask:0xf
k_isd1:
    ds_read2_b32 v[8:9], v4 offset0:0 offset1:4
    ds_read2_b32 v[10:11], v4 offset0:8 offset1:12
    s_setprio 0
    s_cmp_eq_u32 s47, s24
    s_cbranch_scc1 k_switch
k_switched1:
    s_branch k_loop0
k_last0:
    v_mul_f32_e32 v5, 0xbe38aa3b, v5
    v_exp_f32_e32 v5, v5
    s_nop 0
    v_add_f32_e32 v5, 1.0, v5
    v_rcp_f32_e32 v5, v5
    s_nop 0
    v_cvt_pk_bf16_f32 v5, v5, v5
    s_nop 1
    v_and_b32_dpp v16, v5, v2 quad_perm:[0,0,0,0] row_mask:0xf bank_mask:0xf
    v_and_b32_dpp v17, v5, v3 quad_perm:[0,0,0,0] row_mask:0xf bank_mask:0xf
    v_and_b32_dpp v18, v5, v2 quad_perm:[1,1,1,1] row_mask:0xf bank_mask:0xf
    v_and_b32_dpp v19, v5, v3 quad_perm:[1,1,1,1] row_mask:0xf bank_mask:0xf
    v_mfma_f32_4x4x4_16b_bf16 v[48:51], v[16:17], v[64:65], v[48:51]
    v_and_b32_dpp v20, v5, v2 quad_perm:[2,2,2,2] row_mask:0xf bank_mask:0xf
    v_mfma_f32_4x4x4_16b_bf16 v[52:55], v[16:17], v[66:67], v[52:55]
    v_and_b32_dpp v21, v5, v3 quad_perm:[2,2,2,2] row_mask:0xf bank_mask:0xf
    v_mfma_f32_4x4x4_16b_bf16 v[56:59], v[16:17], v[68:69], v[56:59]
    v_mfma_f32_4x4x4_16b_bf16 v[60:63], v[16:17], v[70:71], v[60:63]
    s_cmp_le_u32 s46, 1
    s_cbranch_scc1 k_lastd
    v_mfma_f32_4x4x4_16b_bf16 v[48:51], v[18:19], v[72:73], v[48:51]
    v_and_b32_dpp v22, v5, v2 quad_perm:[3,3,3,3] row_mask:0xf bank_mask:0xf
    v_mfma_f32_4x4x4_16b_bf16 v[52:55], v[18:19], v[74:75], v[52:55]
    v_and_b32_dpp v23, v5, v3 quad_perm:[3,3,3,3] row_mask:0xf bank_mask:0xf
    v_mfma_f32_4x4x4_16b_bf16 v[56:59], v[18:19], v[76:77], v[56:59]
    v_mfma_f32_4x4x4_16b_bf16 v[60:63], v[18:19], v[78:79], v[60:63]
    s_cmp_le_u32 s46, 2
    s_cbranch_scc1 k_lastd
    v_mfma_f32_4x4x4_16b_bf16 v[48:51], v[20:21], v[80:81], v[48:51]
    v_mfma_f32_4x4x4_16b_bf16 v[52:55], v[20:21], v[82:83], v[52:55]
    v_mfma_f32_4x4x4_16b_bf16 v[56:59], v[20:21], v[84:85], v[56:59]
    v_mfma_f32_4x4x4_16b_bf16 v[60:63], v[20:21], v[86:87], v[60:63]
    s_cmp_le_u32 s46, 3
    s_cbranch_scc1 k_lastd
    v_mfma_f32_4x4x4_16b_bf16 v[48:51], v[22:23], v[88:89], v[48:51]
    v_mfma_f32_4x4x4_16b_bf16 v[52:55], v[22:23], v[90:91], v[52:55]
    v_mfma_f32_4x4x4_16b_bf16 v[56:59], v[22:23], v[92:93], v[56:59]
    v_mfma_f32_4x4x4_16b_bf16 v[60:63], v[22:23], v[94:95], v[60:63]
    s_branch k_lastd
k_last1:
    v_mul_f32_e32 v5, 0xbe38aa3b, v5
    v_exp_f32_e32 v5, v5
    s_nop 0
    v_add_f32_e32 v5, 1.0, v5
    v_rcp_f32_e32 v5, v5
    s_nop 0
    v_cvt_pk_bf16_f32 v5, v5, v5
    s_nop 1
    v_and_b32_dpp v16, v5, v2 quad_perm:[0,0,0,0] row_mask:0xf bank_mask:0xf
    v_and_b32_dpp v17, v5, v3 quad_perm:[0,0,0,0] row_mask:0xf bank_mask:0xf
    v_and_b32_dpp v18, v5, v2 quad_perm:[1,1,1,1] row_mask:0xf bank_mask:0xf
    v_and_b32_dpp v19, v5, v3 quad_perm:[1,1,1,1] row_mask:0xf bank_mask:0xf
    v_mfma_f32_4x4x4_16b_bf16 v[48:51], v[16:17], v[96:97], v[48:51]
    v_and_b32_dpp v20, v5, v2 quad_perm:[2,2,2,2] row_mask:0xf bank_mask:0xf
    v_mfma_f32_4x4x4_16b_bf16 v[52:55], v[16:17], v[98:99], v[52:55]
    v_and_b32_dpp v21, v5, v3 quad_perm:[2,2,2,2] row_mask:0xf bank_mask:0xf
    v_mfma_f32_4x4x4_16b_bf16 v[56:59], v[16:17], v[100:101], v[56:59]
    v_mfma_f32_4x4x4_16b_bf16 v[60:63], v[16:17], v[102:103], v[60:63]
    s_cmp_le_u32 s46, 1
    s_cbranch_scc1 k_lastd
    v_mfma_f32_4x4x4_16b_bf16 v[48:51], v[18:19], v[104:105], v[48:51]
    v_and_b32_dpp v22, v5, v2 quad_perm:[3,3,3,3] row_mask:0xf bank_mask:0xf
    v_mfma_f32_4x4x4_16b_bf16 v[52:55], v[18:19], v[106:107], v[52:55]
    v_and_b32_dpp v23, v5, v3 quad_perm:[3,3,3,3] row_mask:0xf bank_mask:0xf
    v_mfma_f32_4x4x4_16b_bf16 v[56:59], v[18:19], v[108:109], v[56:59]
    v_mfma_f32_4x4x4_16b_bf16 v[60:63], v[18:19], v[110:111], v[60:63]
    s_cmp_le_u32 s46, 2
    s_cbranch_scc1 k_lastd
    v_mfma_f32_4x4x4_16b_bf16 v[48:51], v[20:21], v[112:113], v[48:51]
    v_mfma_f32_4x4x4_16b_bf16 v[52:55], v[20:21], v[114:115], v[52:55]
    v_mfma_f32_4x4x4_16b_bf16 v[56:59], v[20:21], v[116:117], v[56:59]
    v_mfma_f32_4x4x4_16b_bf16 v[60:63], v[20:21], v[118:119], v[60:63]
    s_cmp_le_u32 s46, 3
    s_cbranch_scc1 k_lastd
    v_mfma_f32_4x4x4_16b_bf16 v[48:51], v[22:23], v[120:121], v[48:51]
    v_mfma_f32_4x4x4_16b_bf16 v[52:55], v[22:23], v[122:123], v[52:55]
    v_mfma_f32_4x4x4_16b_bf16 v[56:59], v[22:23], v[124:125], v[56:59]
    v_mfma_f32_4x4x4_16b_bf16 v[60:63], v[22:23], v[126:127], v[60:63]
k_lastd:
    s_cmp_eq_u32 s47, s24
    s_cbranch_scc1 k_lastsw
k_gdone:
    s_waitcnt lgkmcnt(0)
    v_mov_b32 v9, 23548
    ds_read_b32 v8, v9
    ds_read_b128 v[12:15], v7 offset:32512
    v_add_f32_dpp v48, v48, v48 row_ror:8 row_mask:0xf bank_mask:0x3
    v_add_f32_dpp v49, v49, v49 row_ror:8 row_mask:0xf bank_mask:0x3
    v_add_f32_dpp v50, v50, v50 row_ror:8 row_mask:0xf bank_mask:0x3
    v_add_f32_dpp v51, v51, v51 row_ror:8 row_mask:0xf bank_mask:0x3
    v_add_f32_dpp v52, v52, v52 row_ror:8 row_mask:0xf bank_mask:0x3
    v_add_f32_dpp v53, v53, v53 row_ror:8 row_mask:0xf bank_mask:0x3
    v_add_f32_dpp v54, v54, v54 row_ror:8 row_mask:0xf bank_mask:0x3
    v_add_f32_dpp v55, v55, v55 row_ror:8 row_mask:0xf bank_mask:0x3
    v_add_f32_dpp v48, v56, v56 row_ror:8 row_mask:0xf bank_mask:0xc
    v_add_f32_dpp v49, v57, v57 row_ror:8 row_mask:0xf bank_mask:0xc
    v_add_f32_dpp v50, v58, v58 row_ror:8 row_mask:0xf bank_mask:0xc
    v_add_f32_dpp v51, v59, v59 row_ror:8 row_mask:0xf bank_mask:0xc
    v_add_f32_dpp v52, v60, v60 row_ror:8 row_mask:0xf bank_mask:0xc
    v_add_f32_dpp v53, v61, v61 row_ror:8 row_mask:0xf bank_mask:0xc
    v_add_f32_dpp v54, v62, v62 row_ror:8 row_mask:0xf bank_mask:0xc
    v_add_f32_dpp v55, v63, v63 row_ror:8 row_mask:0xf bank_mask:0xc
    v_add_f32_dpp v48, v48, v48 row_shl:4 row_mask:0xf bank_mask:0x5
    v_add_f32_dpp v49, v49, v49 row_shl:4 row_mask:0xf bank_mask:0x5
    v_add_f32_dpp v50, v50, v50 row_shl:4 row_mask:0xf bank_mask:0x5
    v_add_f32_dpp v51, v51, v51 row_shl:4 row_mask:0xf bank_mask:0x5
    v_add_f32_dpp v48, v52, v52 row_shr:4 row_mask:0xf bank_mask:0xa
    v_add_f32_dpp v49, v53, v53 row_shr:4 row_mask:0xf bank_mask:0xa
    v_add_f32_dpp v50, v54, v54 row_shr:4 row_mask:0xf bank_mask:0xa
    v_add_f32_dpp v51, v55, v55 row_shr:4 row_mask:0xf bank_mask:0xa
    v_lshrrev_b32 v10, 1, v7
    s_or_b32 s79, s76, s78
    s_waitcnt lgkmcnt(0)
    v_cmp_gt_u32 vcc, 10, v8
    s_cbranch_vccnz k_aflwait
k_aflok:
    v_add_f32 v12, v12, v48
    v_add_f32 v13, v13, v49
    v_add_f32 v14, v14, v50
    v_add_f32 v15, v15, v51
    s_cmp_lg_u32 s79, 0
    s_cbranch_scc1 k_rawflush
k_pack:
    v_cvt_pk_bf16_f32 v12, v12, v13
    v_cvt_pk_bf16_f32 v13, v14, v15
    ds_write_b64 v10, v[12:13] offset:46336
    s_waitcnt lgkmcnt(0)
    s_barrier
    s_branch k_tail2
k_flushed:
    s_or_b32 s3, s76, s78
    s_cmp_lg_u32 s3, 0
    s_cbranch_scc1 k_rare
k_hfinal:
    v_bfe_u32 v125, v0, 4, 2
    v_bfe_u32 v20, v0, 2, 2
    v_lshl_add_u32 v21, v125, 3, v20
    v_lshlrev_b32 v21, 7, v21
    s_and_b32 s3, s26, 1
    s_lshl_b32 s3, s3, 6
    v_add3_u32 v21, v21, v1, s3
    ds_read_b64_tr_b16 v[24:25], v21 offset:8192
    ds_read_b64_tr_b16 v[26:27], v21 offset:8704
    ds_read_b64_tr_b16 v[28:29], v21 offset:12288
    ds_read_b64_tr_b16 v[30:31], v21 offset:12800
    ds_read_b64_tr_b16 v[32:33], v21 offset:8200
    ds_read_b64_tr_b16 v[34:35], v21 offset:8712
    ds_read_b64_tr_b16 v[36:37], v21 offset:12296
    ds_read_b64_tr_b16 v[38:39], v21 offset:12808
    v_and_b32 v20, 15, v0
    v_add_u32 v20, s101, v20
    v_mul_u32_u24 v21, 144, v20
    v_lshl_add_u32 v21, v125, 4, v21
    s_mul_i32 s79, s2, 40
    v_add_lshl_u32 v22, v20, s79, 7
    v_lshl_add_u32 v22, v125, 4, v22
    v_add_u32 v22, s3, v22
    v_cmp_gt_u32 vcc, 40, v20
    s_waitcnt lgkmcnt(0)
    s_barrier
    ds_read_b128 v[96:99], v21 offset:46336
    ds_read_b128 v[100:103], v21 offset:46400
    s_waitcnt lgkmcnt(1)
    v_mfma_f32_16x16x32_bf16 v[80:83], v[24:27], v[96:99], 0
    v_mfma_f32_16x16x32_bf16 v[84:87], v[32:35], v[96:99], 0
    s_waitcnt lgkmcnt(0)
    v_mfma_f32_16x16x32_bf16 v[80:83], v[28:31], v[100:103], v[80:83]
    v_mfma_f32_16x16x32_bf16 v[84:87], v[36:39], v[100:103], v[84:87]
    s_nop 6
    v_cvt_pk_bf16_f32 v88, v80, v81
    v_cvt_pk_bf16_f32 v89, v82, v83
    v_cvt_pk_bf16_f32 v90, v84, v85
    v_cvt_pk_bf16_f32 v91, v86, v87
    s_mov_b64 exec, vcc
    buffer_store_dwordx4 v[88:91], v22, s[36:39], 0 offen
    s_cmp_eq_u32 s44, 15
    s_cbranch_scc0 k_tail2
    s_cmp_eq_u32 s2, 0
    s_cbranch_scc0 k_tail2
    s_mov_b64 exec, 1
    v_mov_b32 v120, s100
    v_mov_b32 v121, 0
    global_store_dword v121, v120, s[18:19] sc0 sc1
k_tail2:
k_end:
    s_endpgm
k_switch:
    v_add_f32_dpp v48, v48, v48 row_ror:8 row_mask:0xf bank_mask:0x3
    v_add_f32_dpp v49, v49, v49 row_ror:8 row_mask:0xf bank_mask:0x3
    v_add_f32_dpp v50, v50, v50 row_ror:8 row_mask:0xf bank_mask:0x3
    v_add_f32_dpp v51, v51, v51 row_ror:8 row_mask:0xf bank_mask:0x3
    v_add_f32_dpp v52, v52, v52 row_ror:8 row_mask:0xf bank_mask:0x3
    v_add_f32_dpp v53, v53, v53 row_ror:8 row_mask:0xf bank_mask:0x3
    v_add_f32_dpp v54, v54, v54 row_ror:8 row_mask:0xf bank_mask:0x3
    v_add_f32_dpp v55, v55, v55 row_ror:8 row_mask:0xf bank_mask:0x3
    v_add_f32_dpp v48, v56, v56 row_ror:8 row_mask:0xf bank_mask:0xc
    v_add_f32_dpp v49, v57, v57 row_ror:8 row_mask:0xf bank_mask:0xc
    v_add_f32_dpp v50, v58, v58 row_ror:8 row_mask:0xf bank_mask:0xc
    v_add_f32_dpp v51, v59, v59 row_ror:8 row_mask:0xf bank_mask:0xc
    v_add_f32_dpp v52, v60, v60 row_ror:8 row_mask:0xf bank_mask:0xc
    v_add_f32_dpp v53, v61, v61 row_ror:8 row_mask:0xf bank_mask:0xc
    v_add_f32_dpp v54, v62, v62 row_ror:8 row_mask:0xf bank_mask:0xc
    v_add_f32_dpp v55, v63, v63 row_ror:8 row_mask:0xf bank_mask:0xc
    v_add_f32_dpp v48, v48, v48 row_shl:4 row_mask:0xf bank_mask:0x5
    v_add_f32_dpp v49, v49, v49 row_shl:4 row_mask:0xf bank_mask:0x5
    v_add_f32_dpp v50, v50, v50 row_shl:4 row_mask:0xf bank_mask:0x5
    v_add_f32_dpp v51, v51, v51 row_shl:4 row_mask:0xf bank_mask:0x5
    v_add_f32_dpp v48, v52, v52 row_shr:4 row_mask:0xf bank_mask:0xa
    v_add_f32_dpp v49, v53, v53 row_shr:4 row_mask:0xf bank_mask:0xa
    v_add_f32_dpp v50, v54, v54 row_shr:4 row_mask:0xf bank_mask:0xa
    v_add_f32_dpp v51, v55, v55 row_shr:4 row_mask:0xf bank_mask:0xa
k_switch1:
    ds_write_b128 v7, v[48:51] offset:32512
    v_mov_b32 v12, 1
    v_mov_b32 v13, 23548
    s_mov_b64 exec, 1
    ds_add_u32 v13, v12
    s_mov_b64 exec, -1
k_switch2:
    v_lshrrev_b32 v13, 4, v0
    v_sub_u32 v13, v6, v13
    s_movk_i32 s24, 288
    v_mad_i32_i24 v7, v13, s24, v7
    v_mov_b32 v48, 0
    v_mov_b32 v49, 0
    v_mov_b32 v50, 0
    v_mov_b32 v51, 0
    v_mov_b32 v52, 0
    v_mov_b32 v53, 0
    v_mov_b32 v54, 0
    v_mov_b32 v55, 0
    v_mov_b32 v56, 0
    v_mov_b32 v57, 0
    v_mov_b32 v58, 0
    v_mov_b32 v59, 0
    v_mov_b32 v60, 0
    v_mov_b32 v61, 0
    v_mov_b32 v62, 0
    v_mov_b32 v63, 0
    s_mov_b32 s24, -1
    s_cmp_lg_u32 s30, 0
    s_cbranch_scc1 k_swx
    s_bitcmp1_b32 s47, 0
    s_cbranch_scc1 k_switched0
    s_branch k_switched1
k_swx:
    s_cmp_eq_u32 s30, 2
    s_mov_b32 s30, 0
    s_cbranch_scc1 k_gdone
    s_cmp_lt_u32 s47, s75
    s_cbranch_scc0 k_gdone
    ds_read2_b32 v[8:9], v4 offset0:0 offset1:4
    ds_read2_b32 v[10:11], v4 offset0:8 offset1:12
    s_branch k_pstart
k_lastsw:
    s_mov_b32 s30, 2
    s_nop 3
    s_branch k_switch
k_resolve:
    v_mov_b32 v13, 23528
    v_lshrrev_b32 v12, 4, v0
    v_lshlrev_b32 v12, 3, v12
    ds_read_b32 v14, v13 offset:8
    s_waitcnt lgkmcnt(0)
    v_readfirstlane_b32 s3, v14
    s_nop 0
    s_cmp_eq_u32 s3, 0
    s_cbranch_scc1 k_claim
k_rdy:
    ds_read_b64 v[14:15], v12 offset:24832
    ds_read_b32 v13, v13
    s_cmp_eq_u32 s3, 2
    s_cbranch_scc1 k_ovf
    v_bfe_u32 v12, v0, 2, 2
    s_waitcnt lgkmcnt(0)
    v_lshrrev_b32 v6, 24, v14
    v_and_b32 v4, 0xffffff, v14
    v_lshl_add_u32 v4, v12, 2, v4
    v_readfirstlane_b32 s76, v13
    ds_read2_b32 v[8:9], v4 offset0:0 offset1:4
    ds_read2_b32 v[10:11], v4 offset0:8 offset1:12
    v_mul_u32_u24 v12, 144, v6
    v_add_u32 v12, v12, v1
    ds_read_b128 v[40:43], v12 offset:25600
    ds_read_b128 v[44:47], v12 offset:25664
    v_readlane_b32 s60, v15, 0
    v_readlane_b32 s61, v15, 16
    v_readlane_b32 s62, v15, 32
    v_readlane_b32 s63, v15, 48
    s_nop 1
    s_max_u32 s60, s60, s61
    s_max_u32 s62, s62, s63
    s_max_u32 s60, s60, s62
    s_add_u32 s60, s60, 15
    s_lshr_b32 s60, s60, 4
    s_add_u32 s61, s60, 3
    s_lshr_b32 s61, s61, 2
    s_add_u32 s45, s75, s61
    s_sub_u32 s46, s60, 1
    s_and_b32 s46, s46, 3
    s_add_u32 s46, s46, 1
    s_mov_b32 s31, 1
    s_setpc_b64 s[64:65]
k_claim:
k_rwait:
k_rspin:
    ds_read_b32 v14, v13 offset:8
    s_waitcnt lgkmcnt(0)
    v_readfirstlane_b32 s3, v14
    s_nop 0
    s_cmp_eq_u32 s3, 0
    s_cbranch_scc1 k_rspin
    s_branch k_rdy
k_rawflush:
    ds_write_b128 v7, v[12:15] offset:32512
    s_branch k_rare
k_aflwait:
k_aspin:
    ds_read_b32 v8, v9 offset:0
    s_waitcnt lgkmcnt(0)
    v_readfirstlane_b32 s3, v8
    s_nop 0
    s_cmp_lt_u32 s3, 10
    s_cbranch_scc1 k_aspin
    ds_read_b128 v[12:15], v7 offset:32512
    s_waitcnt lgkmcnt(0)
    s_branch k_aflok
k_final:
    s_cmp_ge_u32 s44, 10
    s_cbranch_scc1 k_hfinal
    s_waitcnt lgkmcnt(0)
    ds_read_b128 v[12:15], v7 offset:32512
    v_lshrrev_b32 v10, 1, v7
    s_waitcnt lgkmcnt(0)
    s_branch k_pack
k_nf0:
    v_mfma_f32_4x4x4_16b_bf16 v[48:51], v[16:17], v[64:65], v[48:51]
    v_mfma_f32_4x4x4_16b_bf16 v[52:55], v[16:17], v[66:67], v[52:55]
    v_cndmask_b32_e64 v12, v24, v29, s[48:49]
    v_mfma_f32_4x4x4_16b_bf16 v[56:59], v[16:17], v[68:69], v[56:59]
    v_cndmask_b32_e64 v13, v34, v39, s[48:49]
    v_mfma_f32_4x4x4_16b_bf16 v[60:63], v[16:17], v[70:71], v[60:63]
    v_cndmask_b32_e64 v14, v28, v33, s[48:49]
    v_mfma_f32_4x4x4_16b_bf16 v[48:51], v[18:19], v[72:73], v[48:51]
    v_cndmask_b32_e64 v15, v38, v27, s[48:49]
    v_mfma_f32_4x4x4_16b_bf16 v[52:55], v[18:19], v[74:75], v[52:55]
    v_cndmask_b32_e64 v12, v12, v13, s[50:51]
    v_mfma_f32_4x4x4_16b_bf16 v[56:59], v[18:19], v[76:77], v[56:59]
    v_cndmask_b32_e64 v13, v14, v15, s[50:51]
    v_mfma_f32_4x4x4_16b_bf16 v[60:63], v[18:19], v[78:79], v[60:63]
    v_cndmask_b32_e64 v14, v32, v37, s[48:49]
    v_mfma_f32_4x4x4_16b_bf16 v[48:51], v[20:21], v[80:81], v[48:51]
    v_cndmask_b32_e64 v15, v26, v31, s[48:49]
    v_mfma_f32_4x4x4_16b_bf16 v[52:55], v[20:21], v[82:83], v[52:55]
    v_add_f32_dpp v12, v13, v12 quad_perm:[3,0,1,2] row_mask:0xf bank_mask:0xf
    v_mfma_f32_4x4x4_16b_bf16 v[56:59], v[20:21], v[84:85], v[56:59]
    v_cndmask_b32_e64 v14, v14, v15, s[50:51]
    v_mfma_f32_4x4x4_16b_bf16 v[60:63], v[20:21], v[86:87], v[60:63]
    v_cndmask_b32_e64 v13, v36, v25, s[48:49]
    v_mfma_f32_4x4x4_16b_bf16 v[48:51], v[22:23], v[88:89], v[48:51]
    v_cndmask_b32_e64 v15, v30, v35, s[48:49]
    v_mfma_f32_4x4x4_16b_bf16 v[52:55], v[22:23], v[90:91], v[52:55]
    v_add_f32_dpp v12, v14, v12 quad_perm:[2,3,0,1] row_mask:0xf bank_mask:0xf
    v_mfma_f32_4x4x4_16b_bf16 v[56:59], v[22:23], v[92:93], v[56:59]
    v_cndmask_b32_e64 v13, v13, v15, s[50:51]
    v_mfma_f32_4x4x4_16b_bf16 v[60:63], v[22:23], v[94:95], v[60:63]
    s_nop 0
    v_add_f32_dpp v5, v13, v12 quad_perm:[1,2,3,0] row_mask:0xf bank_mask:0xf
    s_cmp_eq_u32 s3, 0
    s_cbranch_scc1 k_gi_endn0
    buffer_load_dwordx4 v[64:67], v8, s[20:23], 0 offen
    buffer_load_dwordx4 v[68:71], v8, s[20:23], 0 offen offset:64
    s_cmp_gt_u32 s3, 1
    s_cbranch_scc1 k_gi_ld1n0
    v_mov_b32 v72, 0
    v_mov_b32 v73, 0
    v_mov_b32 v74, 0
    v_mov_b32 v75, 0
    v_mov_b32 v76, 0
    v_mov_b32 v77, 0
    v_mov_b32 v78, 0
    v_mov_b32 v79, 0
    s_branch k_gi_nx1n0
k_gi_ld1n0:
    buffer_load_dwordx4 v[72:75], v9, s[20:23], 0 offen
    buffer_load_dwordx4 v[76:79], v9, s[20:23], 0 offen offset:64
k_gi_nx1n0:
    s_cmp_gt_u32 s3, 2
    s_cbranch_scc1 k_gi_ld2n0
    v_mov_b32 v80, 0
    v_mov_b32 v81, 0
    v_mov_b32 v82, 0
    v_mov_b32 v83, 0
    v_mov_b32 v84, 0
    v_mov_b32 v85, 0
    v_mov_b32 v86, 0
    v_mov_b32 v87, 0
    s_branch k_gi_nx2n0
k_gi_ld2n0:
    buffer_load_dwordx4 v[80:83], v10, s[20:23], 0 offen
    buffer_load_dwordx4 v[84:87], v10, s[20:23], 0 offen offset:64
k_gi_nx2n0:
    s_cmp_gt_u32 s3, 3
    s_cbranch_scc1 k_gi_ld3n0
    v_mov_b32 v88, 0
    v_mov_b32 v89, 0
    v_mov_b32 v90, 0
    v_mov_b32 v91, 0
    v_mov_b32 v92, 0
    v_mov_b32 v93, 0
    v_mov_b32 v94, 0
    v_mov_b32 v95, 0
    s_branch k_gi_nx3n0
k_gi_ld3n0:
    buffer_load_dwordx4 v[88:91], v11, s[20:23], 0 offen
    buffer_load_dwordx4 v[92:95], v11, s[20:23], 0 offen offset:64
k_gi_nx3n0:
k_gi_endn0:
    s_branch k_isd0
k_nf1:
    v_mfma_f32_4x4x4_16b_bf16 v[48:51], v[16:17], v[96:97], v[48:51]
    v_mfma_f32_4x4x4_16b_bf16 v[52:55], v[16:17], v[98:99], v[52:55]
    v_cndmask_b32_e64 v12, v24, v29, s[48:49]
    v_mfma_f32_4x4x4_16b_bf16 v[56:59], v[16:17], v[100:101], v[56:59]
    v_cndmask_b32_e64 v13, v34, v39, s[48:49]
    v_mfma_f32_4x4x4_16b_bf16 v[60:63], v[16:17], v[102:103], v[60:63]
    v_cndmask_b32_e64 v14, v28, v33, s[48:49]
    v_mfma_f32_4x4x4_16b_bf16 v[48:51], v[18:19], v[104:105], v[48:51]
    v_cndmask_b32_e64 v15, v38, v27, s[48:49]
    v_mfma_f32_4x4x4_16b_bf16 v[52:55], v[18:19], v[106:107], v[52:55]
    v_cndmask_b32_e64 v12, v12, v13, s[50:51]
    v_mfma_f32_4x4x4_16b_bf16 v[56:59], v[18:19], v[108:109], v[56:59]
    v_cndmask_b32_e64 v13, v14, v15, s[50:51]
    v_mfma_f32_4x4x4_16b_bf16 v[60:63], v[18:19], v[110:111], v[60:63]
    v_cndmask_b32_e64 v14, v32, v37, s[48:49]
    v_mfma_f32_4x4x4_16b_bf16 v[48:51], v[20:21], v[112:113], v[48:51]
    v_cndmask_b32_e64 v15, v26, v31, s[48:49]
    v_mfma_f32_4x4x4_16b_bf16 v[52:55], v[20:21], v[114:115], v[52:55]
    v_add_f32_dpp v12, v13, v12 quad_perm:[3,0,1,2] row_mask:0xf bank_mask:0xf
    v_mfma_f32_4x4x4_16b_bf16 v[56:59], v[20:21], v[116:117], v[56:59]
    v_cndmask_b32_e64 v14, v14, v15, s[50:51]
    v_mfma_f32_4x4x4_16b_bf16 v[60:63], v[20:21], v[118:119], v[60:63]
    v_cndmask_b32_e64 v13, v36, v25, s[48:49]
    v_mfma_f32_4x4x4_16b_bf16 v[48:51], v[22:23], v[120:121], v[48:51]
    v_cndmask_b32_e64 v15, v30, v35, s[48:49]
    v_mfma_f32_4x4x4_16b_bf16 v[52:55], v[22:23], v[122:123], v[52:55]
    v_add_f32_dpp v12, v14, v12 quad_perm:[2,3,0,1] row_mask:0xf bank_mask:0xf
    v_mfma_f32_4x4x4_16b_bf16 v[56:59], v[22:23], v[124:125], v[56:59]
    v_cndmask_b32_e64 v13, v13, v15, s[50:51]
    v_mfma_f32_4x4x4_16b_bf16 v[60:63], v[22:23], v[126:127], v[60:63]
    s_nop 0
    v_add_f32_dpp v5, v13, v12 quad_perm:[1,2,3,0] row_mask:0xf bank_mask:0xf
    s_cmp_eq_u32 s3, 0
    s_cbranch_scc1 k_gi_endn1
    buffer_load_dwordx4 v[96:99], v8, s[20:23], 0 offen
    buffer_load_dwordx4 v[100:103], v8, s[20:23], 0 offen offset:64
    s_cmp_gt_u32 s3, 1
    s_cbranch_scc1 k_gi_ld1n1
    v_mov_b32 v104, 0
    v_mov_b32 v105, 0
    v_mov_b32 v106, 0
    v_mov_b32 v107, 0
    v_mov_b32 v108, 0
    v_mov_b32 v109, 0
    v_mov_b32 v110, 0
    v_mov_b32 v111, 0
    s_branch k_gi_nx1n1
k_gi_ld1n1:
    buffer_load_dwordx4 v[104:107], v9, s[20:23], 0 offen
    buffer_load_dwordx4 v[108:111], v9, s[20:23], 0 offen offset:64
k_gi_nx1n1:
    s_cmp_gt_u32 s3, 2
    s_cbranch_scc1 k_gi_ld2n1
    v_mov_b32 v112, 0
    v_mov_b32 v113, 0
    v_mov_b32 v114, 0
    v_mov_b32 v115, 0
    v_mov_b32 v116, 0
    v_mov_b32 v117, 0
    v_mov_b32 v118, 0
    v_mov_b32 v119, 0
    s_branch k_gi_nx2n1
k_gi_ld2n1:
    buffer_load_dwordx4 v[112:115], v10, s[20:23], 0 offen
    buffer_load_dwordx4 v[116:119], v10, s[20:23], 0 offen offset:64
k_gi_nx2n1:
    s_cmp_gt_u32 s3, 3
    s_cbranch_scc1 k_gi_ld3n1
    v_mov_b32 v120, 0
    v_mov_b32 v121, 0
    v_mov_b32 v122, 0
    v_mov_b32 v123, 0
    v_mov_b32 v124, 0
    v_mov_b32 v125, 0
    v_mov_b32 v126, 0
    v_mov_b32 v127, 0
    s_branch k_gi_nx3n1
k_gi_ld3n1:
    buffer_load_dwordx4 v[120:123], v11, s[20:23], 0 offen
    buffer_load_dwordx4 v[124:127], v11, s[20:23], 0 offen offset:64
k_gi_nx3n1:
k_gi_endn1:
    s_branch k_isd1
k_late:
    s_setprio 3
    ds_read_b32 v21, v127
    v_subrev_u32 v126, 640, v0
    s_mov_b32 s79, 0
    s_cmp_eq_u32 s2, 0
    s_cselect_b32 s31, -1, 300
    s_cmp_eq_u64 s[28:29], 0
    s_cbranch_scc1 k_bdoneH
    s_mov_b64 exec, s[28:29]
    s_waitcnt vmcnt(0)
k_bchkH:
    v_xor_b32 v20, s68, v36
    v_bitop3_b32 v20, v20, v37, s69 bitop3:0xf6
    v_bitop3_b32 v20, v20, v38, s70 bitop3:0xf6
    v_bitop3_b32 v20, v20, v39, s71 bitop3:0xf6
    v_and_b32 v20, 14680190, v20
    v_cmp_ne_u32 vcc, 0, v20
    s_cbranch_vccnz k_bretryH
    v_lshrrev_b32 v24, 24, v36
    v_lshrrev_b32 v25, 24, v37
    v_lshrrev_b32 v26, 24, v38
    v_lshrrev_b32 v27, 24, v39
    v_cmpx_gt_u32_e64 s[52:53], s42, v24
    ds_add_rtn_u32 v32, v24, v124 offset:23552
    v_cmpx_gt_u32_e64 s[54:55], s42, v25
    ds_add_rtn_u32 v33, v25, v124 offset:23552
    v_cmpx_gt_u32_e64 s[56:57], s42, v26
    ds_add_rtn_u32 v34, v26, v124 offset:23552
    v_cmpx_gt_u32_e64 s[58:59], s42, v27
    ds_add_rtn_u32 v35, v27, v124 offset:23552
    s_waitcnt lgkmcnt(0)
    ds_write_b32 v35, v39
    s_mov_b64 exec, s[56:57]
    ds_write_b32 v34, v38
    s_mov_b64 exec, s[54:55]
    ds_write_b32 v33, v37
    s_mov_b64 exec, s[52:53]
    ds_write_b32 v32, v36
    s_mov_b64 exec, -1
k_bdoneH:
    s_waitcnt lgkmcnt(0)
    v_readfirstlane_b32 s30, v21
k_lnext:
    s_mov_b64 exec, -1
    v_cmpx_gt_u32 vcc, s30, v126
    s_cbranch_execz k_ldone
    v_lshlrev_b32 v21, 2, v126
    v_add_u32 v21, 89248, v21
    ds_read_b32 v125, v21
    s_waitcnt lgkmcnt(0)
k_lpoll:
    buffer_load_dwordx4 v[8:11], v125, s[32:35], s74 offen sc1
    s_add_u32 s79, s79, 1
    s_waitcnt vmcnt(0)
    v_xor_b32 v20, s68, v8
    v_bitop3_b32 v20, v20, v9, s69 bitop3:0xf6
    v_bitop3_b32 v20, v20, v10, s70 bitop3:0xf6
    v_bitop3_b32 v20, v20, v11, s71 bitop3:0xf6
    v_and_b32 v20, 14680190, v20
    v_cmp_ne_u32_e64 s[28:29], 0, v20
    s_andn2_b64 exec, exec, s[28:29]
    s_cbranch_execz k_lnone
    v_and_b32 v21, 1, v8
    v_cmp_ne_u32_e64 s[62:63], 0, v21
    v_mul_u32_u24 v21, 4194304, v21
    v_cvt_f32_u32 v123, v125
    v_mul_f32 v123, 6.103515625e-05, v123
    v_add_f32 v123, 0.001, v123
    v_cvt_u32_f32 v123, v123
    v_add_u32 v125, v125, v21
    s_or_b64 s[28:29], s[28:29], s[62:63]
    v_lshrrev_b32 v24, 24, v8
    v_lshrrev_b32 v25, 24, v9
    v_lshrrev_b32 v26, 24, v10
    v_lshrrev_b32 v27, 24, v11
    v_cmp_eq_u32 vcc, 0xf8, v24
    s_cbranch_vccnz k_markerL
k_markdoneL:
    v_cmpx_gt_u32_e64 s[52:53], s42, v24
    ds_add_rtn_u32 v32, v24, v124 offset:23552
    v_cmpx_gt_u32_e64 s[54:55], s42, v25
    ds_add_rtn_u32 v33, v25, v124 offset:23552
    v_cmpx_gt_u32_e64 s[56:57], s42, v26
    ds_add_rtn_u32 v34, v26, v124 offset:23552
    v_cmpx_gt_u32_e64 s[58:59], s42, v27
    ds_add_rtn_u32 v35, v27, v124 offset:23552
    s_waitcnt lgkmcnt(0)
    ds_write_b32 v35, v11
    s_mov_b64 exec, s[56:57]
    ds_write_b32 v34, v10
    s_mov_b64 exec, s[54:55]
    ds_write_b32 v33, v9
    s_mov_b64 exec, s[52:53]
    ds_write_b32 v32, v8
k_lnone:
    s_mov_b64 exec, s[28:29]
    s_cbranch_execz k_lstep
    s_cmp_lt_u32 s79, s31
    s_cbranch_scc1 k_lpoll
    ds_write_b32 v127, v12 offset:12
    s_branch k_ldone
k_lstep:
    s_mov_b64 exec, -1
    v_add_u32 v126, 384, v126
    s_branch k_lnext
k_ldone:
    s_mov_b64 exec, 1
    s_waitcnt lgkmcnt(0)
    ds_add_u32 v127, v12 offset:8
    s_mov_b64 exec, -1
    s_cmp_eq_u32 s44, 15
    s_cbranch_scc0 k_hwait
    v_lshlrev_b32 v20, 2, v6
    v_and_b32 v21, 0xfc, v6
    v_mul_u32_u24 v22, 656, v6
    v_add_u32 v22, 94592, v22
k_hspin:
    ds_read_b32 v23, v127 offset:8
    s_waitcnt lgkmcnt(0)
    v_readfirstlane_b32 s3, v23
    s_nop 0
    s_cmp_lt_u32 s3, 16
    s_cbranch_scc1 k_hspin
    ds_read_b32 v24, v20 offset:23552
    ds_read_b32 v25, v21 offset:25152
    ds_read_b32 v26, v127 offset:12
    s_mov_b32 exec_lo, -1
    s_mov_b32 exec_hi, 0xff
    v_mov_b32 v28, -1
    v_mov_b32 v29, 0xff
    v_mov_b32 v30, 0
    s_waitcnt lgkmcnt(0)
    v_sub_u32 v24, v24, v22
    v_lshl_or_b32 v26, v26, 16, v24
    v_cmp_lt_u32 vcc, 512, v26
    v_sub_u32 v27, v24, v25
    s_cmp_eq_u64 vcc, 0
    s_cselect_b32 s79, 1, 2
    v_add_u32 v26, v22, v25
    v_lshl_or_b32 v26, v6, 24, v26
    v_add_u32 v24, 15, v27
    v_lshrrev_b32 v24, 4, v24
    v_min_u32 v24, 15, v24
    v_bfe_i32 v31, v24, 3, 1
    v_cmp_ne_u32 vcc, 0, v31
    s_nop 1
    v_bitop3_b32 v32, v28, vcc_lo, v31 bitop3:0x40
    v_bitop3_b32 v33, v29, vcc_hi, v31 bitop3:0x40
    v_bitop3_b32 v28, v28, vcc_lo, v31 bitop3:0x90
    v_bitop3_b32 v29, v29, vcc_hi, v31 bitop3:0x90
    v_bcnt_u32_b32 v30, v32, v30
    v_bcnt_u32_b32 v30, v33, v30
    v_bfe_i32 v31, v24, 2, 1
    v_cmp_ne_u32 vcc, 0, v31
    s_nop 1
    v_bitop3_b32 v32, v28, vcc_lo, v31 bitop3:0x40
    v_bitop3_b32 v33, v29, vcc_hi, v31 bitop3:0x40
    v_bitop3_b32 v28, v28, vcc_lo, v31 bitop3:0x90
    v_bitop3_b32 v29, v29, vcc_hi, v31 bitop3:0x90
    v_bcnt_u32_b32 v30, v32, v30
    v_bcnt_u32_b32 v30, v33, v30
    v_bfe_i32 v31, v24, 1, 1
    v_cmp_ne_u32 vcc, 0, v31
    s_nop 1
    v_bitop3_b32 v32, v28, vcc_lo, v31 bitop3:0x40
    v_bitop3_b32 v33, v29, vcc_hi, v31 bitop3:0x40
    v_bitop3_b32 v28, v28, vcc_lo, v31 bitop3:0x90
    v_bitop3_b32 v29, v29, vcc_hi, v31 bitop3:0x90
    v_bcnt_u32_b32 v30, v32, v30
    v_bcnt_u32_b32 v30, v33, v30
    v_bfe_i32 v31, v24, 0, 1
    v_cmp_ne_u32 vcc, 0, v31
    s_nop 1
    v_bitop3_b32 v32, v28, vcc_lo, v31 bitop3:0x40
    v_bitop3_b32 v33, v29, vcc_hi, v31 bitop3:0x40
    v_bitop3_b32 v28, v28, vcc_lo, v31 bitop3:0x90
    v_bitop3_b32 v29, v29, vcc_hi, v31 bitop3:0x90
    v_bcnt_u32_b32 v30, v32, v30
    v_bcnt_u32_b32 v30, v33, v30
    v_mbcnt_lo_u32_b32 v30, v28, v30
    v_mbcnt_hi_u32_b32 v30, v29, v30
    v_and_b32 v31, 0x1c, v30
    v_mov_b32 v32, 1410361138
    v_mov_b32 v33, 137
    v_cmp_lt_u32 vcc, 31, v30
    s_nop 1
    v_cndmask_b32 v32, v32, v33, vcc
    v_bfe_u32 v32, v32, v31, 4
    v_and_b32 v30, 3, v30
    v_lshl_or_b32 v30, v32, 2, v30
    v_lshlrev_b32 v30, 3, v30
    ds_write_b64 v30, v[26:27] offset:24832
    v_mov_b32 v24, s79
    s_mov_b64 exec, 1
    s_waitcnt lgkmcnt(0)
    ds_write_b32 v127, v24 offset:4
    s_mov_b64 exec, -1
k_hwait:
k_hspin2:
    ds_read_b32 v21, v127 offset:4
    s_waitcnt lgkmcnt(0)
    v_readfirstlane_b32 s3, v21
    s_nop 0
    s_cmp_eq_u32 s3, 0
    s_cbranch_scc1 k_hspin2
    v_mov_b32 v20, 23528
    ds_read_b32 v21, v20
    s_cmp_eq_u32 s3, 2
    s_cbranch_scc1 k_ovf
    s_waitcnt lgkmcnt(0)
    v_readfirstlane_b32 s76, v21
    s_nop 0
    s_branch k_flushed
k_bigslot:
    s_waitcnt lgkmcnt(0)
    s_mov_b64 s[54:55], vcc
    v_cmp_lt_u32 vcc, 32, v31
    s_and_saveexec_b64 s[52:53], vcc
    v_mov_b32 v116, 4229955456
    v_mov_b32 v117, 4229955456
    v_mov_b32 v118, 4229955456
    v_mov_b32 v119, 4229955456
    s_andn2_b64 s[54:55], s[54:55], exec
    v_cmp_eq_u32 vcc, 0, v1
    s_and_b64 exec, exec, vcc
    v_mov_b32 v116, 4162846592
    s_mov_b64 exec, s[54:55]
    v_or_b32 v116, 1, v116
    v_or_b32 v120, s68, v120
    v_or_b32 v121, s69, v121
    v_or_b32 v122, s70, v122
    v_or_b32 v123, s71, v123
    buffer_store_dwordx4 v[120:123], v113, s[32:35], s73 offen sc1
    s_mov_b64 exec, s[52:53]
    v_or_b32 v116, s68, v116
    v_or_b32 v117, s69, v117
    v_or_b32 v118, s70, v118
    v_or_b32 v119, s71, v119
    buffer_store_dwordx4 v[116:119], v113, s[32:35], s72 offen sc1
    s_branch k_stored
k_pushlate:
    s_and_saveexec_b64 s[62:63], vcc
    s_cmp_lt_u32 s79, 20
    s_cbranch_scc0 k_push2
    buffer_load_dwordx4 v[8:11], v114, s[32:35], s74 offen sc1
    s_add_u32 s79, s79, 1
    s_mov_b64 exec, s[62:63]
    s_waitcnt vmcnt(0)
    s_branch k_recheck
k_push2:
    ds_add_rtn_u32 v22, v127, v12
    s_waitcnt lgkmcnt(0)
    v_lshlrev_b32 v22, 2, v22
    v_add_u32 v22, 89248, v22
    ds_write_b32 v22, v114
    s_andn2_b64 exec, s[62:63], exec
    s_branch k_pushed
k_gslow:
    s_mov_b32 s47, 2
    s_mov_b32 s24, -1
    ds_write_b128 v7, v[48:51] offset:32512
    v_mov_b32 v12, 1
    v_mov_b32 v13, 23548
    s_mov_b64 exec, 1
    ds_add_u32 v13, v12
    s_mov_b64 exec, -1
    s_getpc_b64 s[64:65]
k_pc2:
    s_add_u32 s64, s64, k_rt2-k_pc2
    s_addc_u32 s65, s65, 0
    s_branch k_resolve
k_rt2:
k_gstart:
    s_cmp_lg_u32 s31, 0
    s_cbranch_scc1 k_dc_kp0
    s_getpc_b64 s[64:65]
k_pc3:
    s_add_u32 s64, s64, k_rt3-k_pc3
    s_addc_u32 s65, s65, 0
    s_branch k_resolve
k_rt3:
k_dc_kp0:
    s_mov_b32 s3, 0
    s_cmp_lt_u32 s75, s45
    s_cbranch_scc0 k_dc_endp0
    s_waitcnt lgkmcnt(0)
    v_and_or_b32 v8, v8, s43, v1
    v_and_or_b32 v9, v9, s43, v1
    v_and_or_b32 v10, v10, s43, v1
    v_and_or_b32 v11, v11, s43, v1
    s_add_u32 s75, s75, 1
    v_add_u32 v4, 64, v4
    s_cmp_eq_u32 s75, s45
    s_cselect_b32 s3, s46, 4
k_dc_endp0:
    s_cmp_eq_u32 s3, 0
    s_cbranch_scc1 k_gi_endp0
    buffer_load_dwordx4 v[64:67], v8, s[20:23], 0 offen
    buffer_load_dwordx4 v[68:71], v8, s[20:23], 0 offen offset:64
    s_cmp_gt_u32 s3, 1
    s_cbranch_scc1 k_gi_ld1p0
    v_mov_b32 v72, 0
    v_mov_b32 v73, 0
    v_mov_b32 v74, 0
    v_mov_b32 v75, 0
    v_mov_b32 v76, 0
    v_mov_b32 v77, 0
    v_mov_b32 v78, 0
    v_mov_b32 v79, 0
    s_branch k_gi_nx1p0
k_gi_ld1p0:
    buffer_load_dwordx4 v[72:75], v9, s[20:23], 0 offen
    buffer_load_dwordx4 v[76:79], v9, s[20:23], 0 offen offset:64
k_gi_nx1p0:
    s_cmp_gt_u32 s3, 2
    s_cbranch_scc1 k_gi_ld2p0
    v_mov_b32 v80, 0
    v_mov_b32 v81, 0
    v_mov_b32 v82, 0
    v_mov_b32 v83, 0
    v_mov_b32 v84, 0
    v_mov_b32 v85, 0
    v_mov_b32 v86, 0
    v_mov_b32 v87, 0
    s_branch k_gi_nx2p0
k_gi_ld2p0:
    buffer_load_dwordx4 v[80:83], v10, s[20:23], 0 offen
    buffer_load_dwordx4 v[84:87], v10, s[20:23], 0 offen offset:64
k_gi_nx2p0:
    s_cmp_gt_u32 s3, 3
    s_cbranch_scc1 k_gi_ld3p0
    v_mov_b32 v88, 0
    v_mov_b32 v89, 0
    v_mov_b32 v90, 0
    v_mov_b32 v91, 0
    v_mov_b32 v92, 0
    v_mov_b32 v93, 0
    v_mov_b32 v94, 0
    v_mov_b32 v95, 0
    s_branch k_gi_nx3p0
k_gi_ld3p0:
    buffer_load_dwordx4 v[88:91], v11, s[20:23], 0 offen
    buffer_load_dwordx4 v[92:95], v11, s[20:23], 0 offen offset:64
k_gi_nx3p0:
k_gi_endp0:
    ds_read2_b32 v[8:9], v4 offset0:0 offset1:4
    ds_read2_b32 v[10:11], v4 offset0:8 offset1:12
    s_cmp_lg_u32 s31, 0
    s_cbranch_scc1 k_dc_kp1
    s_getpc_b64 s[64:65]
k_pc4:
    s_add_u32 s64, s64, k_rt4-k_pc4
    s_addc_u32 s65, s65, 0
    s_branch k_resolve
k_rt4:
k_dc_kp1:
    s_mov_b32 s3, 0
    s_cmp_lt_u32 s75, s45
    s_cbranch_scc0 k_dc_endp1
    s_waitcnt lgkmcnt(0)
    v_and_or_b32 v8, v8, s43, v1
    v_and_or_b32 v9, v9, s43, v1
    v_and_or_b32 v10, v10, s43, v1
    v_and_or_b32 v11, v11, s43, v1
    s_add_u32 s75, s75, 1
    v_add_u32 v4, 64, v4
    s_cmp_eq_u32 s75, s45
    s_cselect_b32 s3, s46, 4
k_dc_endp1:
    s_cmp_eq_u32 s3, 0
    s_cbranch_scc1 k_gi_endp1
    buffer_load_dwordx4 v[96:99], v8, s[20:23], 0 offen
    buffer_load_dwordx4 v[100:103], v8, s[20:23], 0 offen offset:64
    s_cmp_gt_u32 s3, 1
    s_cbranch_scc1 k_gi_ld1p1
    v_mov_b32 v104, 0
    v_mov_b32 v105, 0
    v_mov_b32 v106, 0
    v_mov_b32 v107, 0
    v_mov_b32 v108, 0
    v_mov_b32 v109, 0
    v_mov_b32 v110, 0
    v_mov_b32 v111, 0
    s_branch k_gi_nx1p1
k_gi_ld1p1:
    buffer_load_dwordx4 v[104:107], v9, s[20:23], 0 offen
    buffer_load_dwordx4 v[108:111], v9, s[20:23], 0 offen offset:64
k_gi_nx1p1:
    s_cmp_gt_u32 s3, 2
    s_cbranch_scc1 k_gi_ld2p1
    v_mov_b32 v112, 0
    v_mov_b32 v113, 0
    v_mov_b32 v114, 0
    v_mov_b32 v115, 0
    v_mov_b32 v116, 0
    v_mov_b32 v117, 0
    v_mov_b32 v118, 0
    v_mov_b32 v119, 0
    s_branch k_gi_nx2p1
k_gi_ld2p1:
    buffer_load_dwordx4 v[112:115], v10, s[20:23], 0 offen
    buffer_load_dwordx4 v[116:119], v10, s[20:23], 0 offen offset:64
k_gi_nx2p1:
    s_cmp_gt_u32 s3, 3
    s_cbranch_scc1 k_gi_ld3p1
    v_mov_b32 v120, 0
    v_mov_b32 v121, 0
    v_mov_b32 v122, 0
    v_mov_b32 v123, 0
    v_mov_b32 v124, 0
    v_mov_b32 v125, 0
    v_mov_b32 v126, 0
    v_mov_b32 v127, 0
    s_branch k_gi_nx3p1
k_gi_ld3p1:
    buffer_load_dwordx4 v[120:123], v11, s[20:23], 0 offen
    buffer_load_dwordx4 v[124:127], v11, s[20:23], 0 offen offset:64
k_gi_nx3p1:
k_gi_endp1:
    s_waitcnt vmcnt(0) lgkmcnt(0)
    s_mov_b32 s30, 1
    s_branch k_switch2
k_bretryG:
    buffer_load_dwordx4 v[36:39], v125, s[32:35], s74 offen sc1
    s_waitcnt vmcnt(0)
    s_branch k_bchkG
k_bretryH:
    buffer_load_dwordx4 v[36:39], v125, s[32:35], s74 offen sc1
    s_waitcnt vmcnt(0)
    s_branch k_bchkH
k_markerA:
    s_and_saveexec_b64 s[60:61], vcc
    v_mov_b32 v20, 23528
    ds_add_rtn_u32 v21, v20, v12
    v_lshrrev_b32 v20, 2, v0
    s_waitcnt lgkmcnt(0)
    v_lshlrev_b32 v21, 2, v21
    ds_write_b32 v21, v20 offset:23808
    s_waitcnt lgkmcnt(0)
    s_mov_b64 exec, s[60:61]
    s_branch k_markdoneA
k_markerL:
    s_and_saveexec_b64 s[60:61], vcc
    v_mov_b32 v20, 23528
    ds_add_rtn_u32 v21, v20, v12
    v_mov_b32 v20, v123
    s_waitcnt lgkmcnt(0)
    v_lshlrev_b32 v21, 2, v21
    ds_write_b32 v21, v20 offset:23808
    s_waitcnt lgkmcnt(0)
    s_mov_b64 exec, s[60:61]
    s_branch k_markdoneL
k_ovf:
    s_waitcnt vmcnt(0) lgkmcnt(0)
    s_barrier
    v_mov_b32 v48, 0
    v_mov_b32 v49, 0
    v_mov_b32 v50, 0
    v_mov_b32 v51, 0
    v_mov_b32 v52, 0
    v_mov_b32 v53, 0
    v_mov_b32 v54, 0
    v_mov_b32 v55, 0
    v_mov_b32 v56, 0
    v_mov_b32 v57, 0
    v_mov_b32 v58, 0
    v_mov_b32 v59, 0
    v_mov_b32 v60, 0
    v_mov_b32 v61, 0
    v_mov_b32 v62, 0
    v_mov_b32 v63, 0
    v_lshlrev_b32 v126, 4, v0
    v_cmp_gt_u32 vcc, 864, v0
    s_and_saveexec_b64 s[52:53], vcc
    ds_write_b128 v126, v[48:51] offset:32512
    s_mov_b64 exec, s[52:53]
    v_mov_b32 v20, 23548
    v_mov_b32 v21, 10
    ds_write_b32 v20, v21
    s_mov_b32 s27, 1
    s_mov_b32 s76, 250
k_rare:
    v_lshlrev_b32 v126, 4, v0
    v_and_b32 v6, 63, v0
    v_add_u32 v23, 69632, v126
    s_cmp_lg_u32 s78, 0
    s_cbranch_scc0 k_rare1
    ds_read_b128 v[8:11], v23
    s_branch k_slow
k_rare1:
    s_cmp_ge_u32 s77, s76
    s_cbranch_scc1 k_final
    s_lshl_b32 s3, s77, 2
    v_mov_b32 v20, s3
    ds_read_b32 v20, v20 offset:23808
    v_mov_b32 v8, 4229955456
    v_mov_b32 v9, 4229955456
    v_mov_b32 v10, 4229955456
    v_mov_b32 v11, 4229955456
    s_waitcnt lgkmcnt(0)
    s_cmp_eq_u32 s27, 0
    s_cbranch_scc1 k_rare2
    v_mov_b32 v20, s77
k_rare2:
    s_add_u32 s77, s77, 1
    s_cmp_ge_u32 s44, 10
    s_cbranch_scc1 k_slow
    v_min_u32 v20, 249, v20
    v_mul_u32_u24 v20, 10240, v20
    v_add_u32 v20, v20, v126
    global_load_dwordx4 v[100:103], v20, s[8:9]
    global_load_dwordx4 v[96:99], v20, s[6:7]
    s_mul_i32 s3, s2, 40
    s_waitcnt vmcnt(0)
    v_subrev_u32 v100, s3, v100
    v_lshlrev_b32 v96, 7, v96
    v_lshl_or_b32 v96, v100, 26, v96
    v_cmp_gt_u32 vcc, 40, v100
    s_nop 1
    v_cndmask_b32 v8, v8, v96, vcc
    v_subrev_u32 v101, s3, v101
    v_lshlrev_b32 v97, 7, v97
    v_lshl_or_b32 v97, v101, 26, v97
    v_cmp_gt_u32 vcc, 40, v101
    s_nop 1
    v_cndmask_b32 v9, v9, v97, vcc
    v_subrev_u32 v102, s3, v102
    v_lshlrev_b32 v98, 7, v98
    v_lshl_or_b32 v98, v102, 26, v98
    v_cmp_gt_u32 vcc, 40, v102
    s_nop 1
    v_cndmask_b32 v10, v10, v98, vcc
    v_subrev_u32 v103, s3, v103
    v_lshlrev_b32 v99, 7, v99
    v_lshl_or_b32 v99, v103, 26, v99
    v_cmp_gt_u32 vcc, 40, v103
    s_nop 1
    v_cndmask_b32 v11, v11, v99, vcc
k_slow:
    s_mov_b32 s25, 1
    s_waitcnt lgkmcnt(0)
    s_barrier
    v_mov_b32 v16, 4229955456
    v_mov_b32 v17, 4229955456
    v_mov_b32 v18, 4229955456
    v_mov_b32 v19, 4229955456
    v_add_u32 v20, 94592, v126
    ds_write_b128 v20, v[16:19]
    v_cmp_gt_u32 vcc, 616, v0
    s_and_saveexec_b64 s[52:53], vcc
    ds_write_b128 v20, v[16:19] offset:16384
    s_mov_b64 exec, s[52:53]
    v_lshlrev_b32 v14, 2, v6
    v_mul_u32_u24 v13, 656, v6
    v_add_u32 v13, 94592, v13
    ds_write_b32 v14, v13 offset:23552
    v_mov_b32 v22, 25280
    v_mov_b32 v21, 0
    ds_write_b32 v22, v21
    v_mov_b32 v124, 4
    v_mov_b32 v125, 95104
    s_mov_b32 s3, 164
    v_mov_b32 v21, 1
    s_waitcnt lgkmcnt(0)
    s_barrier
    v_lshrrev_b32 v24, 24, v8
    v_cmpx_gt_u32_e64 s[52:53], s42, v24
    ds_add_rtn_u32 v25, v24, v124 offset:23552
    v_mad_u32_u24 v24, v24, s3, v125
    s_waitcnt lgkmcnt(0)
    v_cmpx_lt_u32 vcc, v25, v24
    ds_write_b32 v25, v8
    v_mov_b32 v8, 4229955456
    s_andn2_b64 exec, s[52:53], exec
    ds_write_b32 v22, v21
    s_mov_b64 exec, -1
    v_lshrrev_b32 v24, 24, v9
    v_cmpx_gt_u32_e64 s[52:53], s42, v24
    ds_add_rtn_u32 v25, v24, v124 offset:23552
    v_mad_u32_u24 v24, v24, s3, v125
    s_waitcnt lgkmcnt(0)
    v_cmpx_lt_u32 vcc, v25, v24
    ds_write_b32 v25, v9
    v_mov_b32 v9, 4229955456
    s_andn2_b64 exec, s[52:53], exec
    ds_write_b32 v22, v21
    s_mov_b64 exec, -1
    v_lshrrev_b32 v24, 24, v10
    v_cmpx_gt_u32_e64 s[52:53], s42, v24
    ds_add_rtn_u32 v25, v24, v124 offset:23552
    v_mad_u32_u24 v24, v24, s3, v125
    s_waitcnt lgkmcnt(0)
    v_cmpx_lt_u32 vcc, v25, v24
    ds_write_b32 v25, v10
    v_mov_b32 v10, 4229955456
    s_andn2_b64 exec, s[52:53], exec
    ds_write_b32 v22, v21
    s_mov_b64 exec, -1
    v_lshrrev_b32 v24, 24, v11
    v_cmpx_gt_u32_e64 s[52:53], s42, v24
    ds_add_rtn_u32 v25, v24, v124 offset:23552
    v_mad_u32_u24 v24, v24, s3, v125
    s_waitcnt lgkmcnt(0)
    v_cmpx_lt_u32 vcc, v25, v24
    ds_write_b32 v25, v11
    v_mov_b32 v11, 4229955456
    s_andn2_b64 exec, s[52:53], exec
    ds_write_b32 v22, v21
    s_mov_b64 exec, -1
    ds_write_b128 v23, v[8:11]
    v_lshrrev_b32 v6, 4, v0
    v_mul_u32_u24 v15, 656, v6
    v_add_u32 v15, 94592, v15
    v_bfe_u32 v20, v0, 2, 2
    v_lshl_add_u32 v4, v20, 2, v15
    v_mul_u32_u24 v7, 288, v6
    v_lshl_add_u32 v7, v1, 1, v7
    v_lshrrev_b32 v21, 1, v20
    v_lshl_add_u32 v7, v21, 7, v7
    v_and_b32 v21, 1, v20
    v_lshl_add_u32 v7, v21, 4, v7
    v_lshlrev_b32 v14, 2, v6
    s_mov_b32 s75, 2
    s_mov_b32 s47, 2
    s_waitcnt lgkmcnt(0)
    s_barrier
    ds_read_b32 v13, v14 offset:23552
    ds_read_b32 v26, v22
    ds_read2_b32 v[8:9], v4 offset0:0 offset1:4
    ds_read2_b32 v[10:11], v4 offset0:8 offset1:12
    s_waitcnt lgkmcnt(0)
    v_sub_u32 v13, v13, v15
    v_min_u32 v13, 512, v13
    v_readfirstlane_b32 s78, v26
    s_cmp_ge_u32 s44, 10
    s_cbranch_scc1 k_flushed
    v_readlane_b32 s60, v13, 0
    v_readlane_b32 s61, v13, 16
    v_readlane_b32 s62, v13, 32
    v_readlane_b32 s63, v13, 48
    s_nop 1
    s_max_u32 s60, s60, s61
    s_max_u32 s62, s62, s63
    s_max_u32 s60, s60, s62
    s_add_u32 s60, s60, 15
    s_lshr_b32 s60, s60, 4
    s_add_u32 s61, s60, 3
    s_lshr_b32 s61, s61, 2
    s_add_u32 s45, s75, s61
    s_sub_u32 s46, s60, 1
    s_and_b32 s46, s46, 3
    s_add_u32 s46, s46, 1
    s_mov_b32 s31, 1
    v_mul_u32_u24 v12, 144, v6
    v_add_u32 v12, v12, v1
    ds_read_b128 v[40:43], v12 offset:25600
    ds_read_b128 v[44:47], v12 offset:25664
    s_branch k_gstart
.section .rodata,"a"
.p2align 6
.amdhsa_kernel gather_scatter__kernel_systems_refs_featgraph__graph_kernel
  .amdhsa_next_free_vgpr 128
  .amdhsa_next_free_sgpr 102
  .amdhsa_accum_offset 128
  .amdhsa_group_segment_fixed_size 0
  .amdhsa_kernarg_size 64
  .amdhsa_user_sgpr_count 2
  .amdhsa_user_sgpr_kernarg_segment_ptr 1
  .amdhsa_system_sgpr_workgroup_id_x 1
  .amdhsa_float_denorm_mode_32 3
.end_amdhsa_kernel
```
